```python
import torch

def _softmax(x, axis=-1):
    return torch.softmax(x, dim=axis)
def _gelu(x):
    return torch.nn.functional.gelu(x, approximate="tanh")
def _silu(x):
    return torch.nn.functional.silu(x)
def _sigmoid(x):
    return torch.sigmoid(x)
def _layernorm(x, axis=-1, eps=1e-5):
    m = x.mean(dim=axis, keepdim=True)
    v = x.var(dim=axis, keepdim=True, unbiased=False)
    return (x - m) / torch.sqrt(v + eps)
def _scatter_add(tgt, idx, src, axis=0):
    return tgt.clone().index_add_(axis, idx, src)
def _segment_sum(src, seg, n):
    out = torch.zeros((n,) + src.shape[1:], dtype=src.dtype)
    return out.index_add_(0, seg, src)
def _pad(x, pw):
    flat = tuple(v for pair in reversed(pw) for v in pair)
    return torch.nn.functional.pad(x, flat)

kernel_name = 'gated_mix__sliding_local_dilated__sliding_local_dilated__prompt'

def setup_inputs():

    _w = (lambda a: (lambda t: t.to(torch.bfloat16) if t.is_floating_point() else t)(torch.as_tensor(a)))
    def _A_setup():
        B, S, D = 1, 2048, 512
        return {
            "x": _w((lambda *s: torch.randn(*s, dtype=torch.bfloat16) * 0.05)(B, S, D)),
            "wqkv": _w((lambda *s: torch.randn(*s, dtype=torch.bfloat16) * 0.8)(D, 3 * D)),
            "wo": _w((lambda *s: torch.randn(*s, dtype=torch.bfloat16) * 0.05)(D, D)),
        }
    _A_in = _A_setup()

    def _B_setup():
        B, S, D = 1, 2048, 512
        return {
            "x": _w((lambda *s: torch.randn(*s, dtype=torch.bfloat16) * 0.05)(B, S, D)),
            "wqkv": _w((lambda *s: torch.randn(*s, dtype=torch.bfloat16) * 0.8)(D, 3 * D)),
            "wo": _w((lambda *s: torch.randn(*s, dtype=torch.bfloat16) * 0.05)(D, D)),
        }
    _B_in = _B_setup()

    return {
        "A_x": _A_in["x"],
        "A_wqkv": _A_in["wqkv"],
        "A_wo": _A_in["wo"],
        "B_x": _B_in["x"],
        "B_wqkv": _B_in["wqkv"],
        "B_wo": _B_in["wo"],
        "gate_w": _w((lambda *s: torch.randn(*s, dtype=torch.bfloat16) * 0.05)(512) * 16.0),
    }

def reference(A_x, A_wqkv, A_wo, B_x, B_wqkv, B_wo, gate_w):
    def _A_ref(x, wqkv, wo):
        B, S, D = x.shape
        H = 32; Dh = D // H
        W, dil = 8, 2
        qkv = (lambda x, *d: x.permute(*d))((x @ wqkv).reshape(B, S, 3, H, Dh), 2, 0, 3, 1, 4)
        q, k, v = qkv[0], qkv[1], qkv[2]
        scale = Dh ** -0.5
        pos = torch.arange(S)
        off = torch.arange(W) * dil
        idx = pos[:, None] - off[None, :]
        mask = idx >= 0
        idx_c = torch.where(mask, idx, 0).reshape(-1)
        kg = k[:, :, idx_c, :].reshape(B, H, S, W, Dh)
        vg = v[:, :, idx_c, :].reshape(B, H, S, W, Dh)
        logits = torch.einsum("bhsd,bhswd->bhsw", q, kg) * scale
        logits = torch.where(mask[None, None, :, :], logits, -1e9)
        attn = _softmax(logits, axis=-1)
        o = torch.einsum("bhsw,bhswd->bhsd", attn, vg)
        return (lambda x, *d: x.permute(*d))(o, 0, 2, 1, 3).reshape(B, S, D) @ wo

    def _B_ref(x, wqkv, wo):
        B, S, D = x.shape
        H = 32; Dh = D // H
        W, dil = 8, 2
        qkv = (lambda x, *d: x.permute(*d))((x @ wqkv).reshape(B, S, 3, H, Dh), 2, 0, 3, 1, 4)
        q, k, v = qkv[0], qkv[1], qkv[2]
        scale = Dh ** -0.5
        pos = torch.arange(S)
        off = torch.arange(W) * dil
        idx = pos[:, None] - off[None, :]
        mask = idx >= 0
        idx_c = torch.where(mask, idx, 0).reshape(-1)
        kg = k[:, :, idx_c, :].reshape(B, H, S, W, Dh)
        vg = v[:, :, idx_c, :].reshape(B, H, S, W, Dh)
        logits = torch.einsum("bhsd,bhswd->bhsw", q, kg) * scale
        logits = torch.where(mask[None, None, :, :], logits, -1e9)
        attn = _softmax(logits, axis=-1)
        o = torch.einsum("bhsw,bhswd->bhsd", attn, vg)
        return (lambda x, *d: x.permute(*d))(o, 0, 2, 1, 3).reshape(B, S, D) @ wo

    x = A_x
    g = _sigmoid((x * gate_w).sum(-1, keepdims=True))
    a = _A_ref(x, A_wqkv, A_wo)
    b = _B_ref(x, B_wqkv, B_wo)
    return g * a + (1 - g) * b
```

```asm
; @launch grid=(256,1,1) block=(512,1,1) lds=163840
.amdgcn_target "amdgcn-amd-amdhsa--gfx950"
.text
.p2align 12
.globl gated_mix__sliding_local_dilated__sliding_local_dilated__prompt_kernel
.p2align 8
.type gated_mix__sliding_local_dilated__sliding_local_dilated__prompt_kernel,@function
gated_mix__sliding_local_dilated__sliding_local_dilated__prompt_kernel:
    s_load_dwordx16 s[4:19], s[0:1], 0
    s_load_dwordx4 s[20:23], s[0:1], 64
    s_cmp_ge_u32 s2, 256
    s_cbranch_scc1 K_END
    s_getpc_b64 s[56:57]
L_PC:
    s_lshr_b32 s58, s2, 3
    s_and_b32 s58, s58, 15
    v_lshl_add_u32 v1, s58, 3, v0
    v_cmp_gt_u32 vcc, 8, v0
    v_min_u32 v1, (K_END - L_PC) / 128, v1
    v_lshlrev_b32 v1, 7, v1
    s_and_saveexec_b64 s[58:59], vcc
    s_cbranch_execz L_NOPF
    global_load_dword v255, v1, s[56:57]
L_NOPF:
    s_mov_b64 exec, s[58:59]
    v_lshrrev_b32 v1, 6, v0
    v_and_b32 v0, 63, v0
    s_and_b32 s56, s2, 1
    s_lshr_b32 s57, s2, 3
    v_readfirstlane_b32 s3, v1
    s_and_b32 s57, s57, 7
    s_lshl3_add_u32 s52, s56, s57
    s_lshr_b32 s56, s2, 1
    s_and_b32 s56, s56, 3
    s_lshr_b32 s57, s2, 6
    s_lshl2_add_u32 s53, s56, s57
    s_lshr_b32 s54, s53, 3
    s_and_b32 s55, s53, 7
    s_cmp_ge_u32 s3, 4
    s_cbranch_scc1 K_CONS
K_LOAD:
    v_lshrrev_b32 v1, 3, v0
    v_and_b32 v2, 7, v0
    s_and_b32 s56, s3, 1
    s_lshl_b32 s57, s56, 2
    v_lshrrev_b32 v3, 1, v1
    v_add_u32 v3, s57, v3
    v_xor_b32 v3, v2, v3
    s_lshl_b32 s58, s3, 3
    v_add_u32 v6, s58, v1
    s_lshl_b32 s58, s52, 7
    s_sub_u32 s58, s58, 16
    v_add_u32 v4, s58, v6
    v_lshlrev_b32 v3, 4, v3
    v_max_i32 v5, 0, v4
    v_lshl_add_u32 v16, v5, 10, v3
    v_lshl_add_u32 v5, v4, 10, v3
    v_add_u32 v17, 0x8000, v5
    v_add_u32 v18, 0x10000, v5
    v_add_u32 v19, 0x18000, v5
    v_add_u32 v20, 0x20000, v5
    v_and_b32 v3, 2, v1
    v_or_b32 v3, s57, v3
    v_xor_b32 v3, v2, v3
    v_lshlrev_b32 v7, 4, v3
    v_mul_u32_u24 v4, 3072, v6
    s_lshl_b32 s57, s55, 7
    v_add3_u32 v21, v4, v7, s57
    s_add_u32 s56, s53, s52
    s_mul_i32 s57, s56, 86
    s_lshr_b32 s57, s57, 8
    s_mul_i32 s57, s57, 3
    s_sub_u32 s56, s56, s57
    s_lshl_b32 s56, s56, 2
    s_lshr_b32 s56, 0x630, s56
    s_and_b32 s98, s56, 15
    s_lshl_b32 s100, s3, 10
    s_mov_b32 s26, 0x200000
    s_mov_b32 s27, 0x20000
    s_mov_b32 s30, 0x180000
    s_mov_b32 s31, 0x20000
    s_cmp_eq_u32 s54, 0
    s_waitcnt lgkmcnt(0)
    s_mov_b32 s24, s4
    s_mov_b32 s25, s5
    s_cselect_b32 s28, s6, s12
    s_cselect_b32 s29, s7, s13
    s_add_u32 s56, s98, 0
    s_and_b32 s56, s56, 7
    s_mul_i32 s57, s56, 196608
    s_lshl_b32 s56, s56, 7
    s_cmp_ge_u32 s3, 2
    s_cbranch_scc1 ex_1
    s_add_u32 m0, s100, 59392
    s_nop 0
    buffer_load_dwordx4 v20, s[24:27], s56 offen lds
    s_branch ex_2
ex_1:
    s_cmp_eq_u32 s3, 2
    s_cbranch_scc0 ex_3
    s_mov_b32 m0, 161792
    v_lshlrev_b32 v9, 4, v0
    global_load_lds_dwordx4 v9, s[16:17]
    s_branch ex_2
ex_3:
    s_mov_b64 exec, 1
    buffer_load_dword v31, v16, s[24:27], s56 offen
    s_mov_b64 exec, -1
ex_2:
    s_add_u32 m0, s100, 43008
    s_nop 0
    buffer_load_dwordx4 v16, s[24:27], s56 offen lds
    s_add_u32 m0, s100, 47104
    s_nop 0
    buffer_load_dwordx4 v17, s[24:27], s56 offen lds
    s_add_u32 m0, s100, 51200
    s_nop 0
    buffer_load_dwordx4 v18, s[24:27], s56 offen lds
    s_add_u32 m0, s100, 55296
    s_nop 0
    buffer_load_dwordx4 v19, s[24:27], s56 offen lds
    s_and_b32 s58, s52, 7
    v_mov_b32 v12, v21
    s_cmp_ge_u32 s58, 6
    s_cselect_b32 s59, 6, 0
    s_sub_u32 s58, s58, s59
    s_lshl_b32 s59, s58, 12
    s_add_u32 s4, s59, s100
    s_lshr_b32 s59, s58, 1
    s_lshl_b32 s12, s59, 10
    s_bitcmp1_b32 s58, 0
    s_cselect_b32 s59, 98304, 0
    s_add_u32 s59, s59, s12
    v_add_u32 v21, s59, v12
    s_add_u32 m0, s4, 61440
    s_nop 0
    buffer_load_dwordx4 v21, s[28:31], s57 offen lds
    s_add_u32 s58, s58, 1
    s_cmp_ge_u32 s58, 6
    s_cselect_b32 s59, 6, 0
    s_sub_u32 s58, s58, s59
    s_lshl_b32 s59, s58, 12
    s_add_u32 s5, s59, s100
    s_lshr_b32 s59, s58, 1
    s_lshl_b32 s12, s59, 10
    s_bitcmp1_b32 s58, 0
    s_cselect_b32 s59, 98304, 0
    s_add_u32 s59, s59, s12
    v_add_u32 v22, s59, v12
    s_add_u32 m0, s5, 61440
    s_nop 0
    buffer_load_dwordx4 v22, s[28:31], s57 offen lds
    s_add_u32 s58, s58, 1
    s_cmp_ge_u32 s58, 6
    s_cselect_b32 s59, 6, 0
    s_sub_u32 s58, s58, s59
    s_lshl_b32 s59, s58, 12
    s_add_u32 s6, s59, s100
    s_lshr_b32 s59, s58, 1
    s_lshl_b32 s12, s59, 10
    s_bitcmp1_b32 s58, 0
    s_cselect_b32 s59, 98304, 0
    s_add_u32 s59, s59, s12
    v_add_u32 v23, s59, v12
    s_add_u32 m0, s6, 61440
    s_nop 0
    buffer_load_dwordx4 v23, s[28:31], s57 offen lds
    s_add_u32 s58, s58, 1
    s_cmp_ge_u32 s58, 6
    s_cselect_b32 s59, 6, 0
    s_sub_u32 s58, s58, s59
    s_lshl_b32 s59, s58, 12
    s_add_u32 s7, s59, s100
    s_lshr_b32 s59, s58, 1
    s_lshl_b32 s12, s59, 10
    s_bitcmp1_b32 s58, 0
    s_cselect_b32 s59, 98304, 0
    s_add_u32 s59, s59, s12
    v_add_u32 v24, s59, v12
    s_add_u32 m0, s7, 61440
    s_nop 0
    buffer_load_dwordx4 v24, s[28:31], s57 offen lds
    s_add_u32 s58, s58, 1
    s_cmp_ge_u32 s58, 6
    s_cselect_b32 s59, 6, 0
    s_sub_u32 s58, s58, s59
    s_lshl_b32 s59, s58, 12
    s_add_u32 s10, s59, s100
    s_lshr_b32 s59, s58, 1
    s_lshl_b32 s12, s59, 10
    s_bitcmp1_b32 s58, 0
    s_cselect_b32 s59, 98304, 0
    s_add_u32 s59, s59, s12
    v_add_u32 v25, s59, v12
    s_add_u32 m0, s10, 61440
    s_nop 0
    buffer_load_dwordx4 v25, s[28:31], s57 offen lds
    s_add_u32 s58, s58, 1
    s_cmp_ge_u32 s58, 6
    s_cselect_b32 s59, 6, 0
    s_sub_u32 s58, s58, s59
    s_lshl_b32 s59, s58, 12
    s_add_u32 s11, s59, s100
    s_lshr_b32 s59, s58, 1
    s_lshl_b32 s12, s59, 10
    s_bitcmp1_b32 s58, 0
    s_cselect_b32 s59, 98304, 0
    s_add_u32 s59, s59, s12
    v_add_u32 v26, s59, v12
    s_add_u32 m0, s11, 61440
    s_nop 0
    buffer_load_dwordx4 v26, s[28:31], s57 offen lds
    s_lshr_b32 s57, s2, 3
    s_and_b32 s96, s57, 3
    s_lshr_b32 s97, s57, 2
    s_lshr_b32 s56, s96, 1
    s_lshr_b32 s13, s97, 2
    s_xor_b32 s13, s13, s56
    s_and_b32 s56, s97, 3
    s_lshl_b32 s56, s56, 3
    s_mov_b32 s58, 0x76543210
    s_mov_b32 s59, s58
    s_lshr_b64 s[58:59], s[58:59], s56
    s_mul_i32 s59, s13, 0x88888888
    s_or_b32 s99, s58, s59
    s_lshl_b32 s13, s13, 3
    s_andn2_b32 s56, 1, s2
    s_lshr_b32 s57, s2, 1
    s_and_b32 s57, s57, 3
    s_lshl2_add_u32 s56, s56, s57
    s_lshl2_add_u32 s96, s56, s96
    s_mov_b32 s48, s20
    s_mov_b32 s49, s21
    s_mov_b32 s50, 256
    s_mov_b32 s51, 0x20000
    s_mov_b32 s32, s22
    s_mov_b32 s33, s23
    s_mov_b32 s34, 268435456
    s_mov_b32 s35, 0x20000
    s_bitcmp1_b32 s96, 0
    s_cselect_b32 s40, s14, s8
    s_cselect_b32 s41, s15, s9
    s_cselect_b32 s44, s8, s14
    s_cselect_b32 s45, s9, s15
    s_mov_b32 s42, 0x80000
    s_mov_b32 s43, 0x20000
    s_mov_b32 s46, 0x80000
    s_mov_b32 s47, 0x20000
    s_xor_b32 s12, s99, 0x88888888
    s_add_u32 s16, s98, 7
    s_and_b32 s16, s16, 7
    s_mul_i32 s17, s16, 196608
    s_lshl_b32 s16, s16, 7
    s_lshl_b32 s57, s97, 7
    v_lshl_add_u32 v27, v6, 10, v7
    v_add_u32 v27, s57, v27
    s_lshl_b32 s56, s52, 8
    s_lshl2_add_u32 s56, s53, s56
    s_add_u32 s56, s56, 9437184
    v_mov_b32 v14, s56
    v_mov_b32 v30, 0
    s_lshl_b32 s56, s52, 4
    s_add_u32 s56, s56, 0
    v_mov_b32 v13, s56
    v_mov_b32 v15, 1
    s_lshr_b32 s56, s96, 1
    s_lshl_b32 s57, s56, 4
    s_add_u32 s57, s57, 0
    v_mov_b32 v28, s57
    s_add_u32 s56, s98, 1
    s_and_b32 s56, s56, 7
    s_mul_i32 s57, s56, 196608
    s_lshl_b32 s56, s56, 7
    s_cmp_ge_u32 s3, 2
    s_cbranch_scc1 ex_4
    s_add_u32 m0, s100, 16384
    s_nop 0
    buffer_load_dwordx4 v20, s[24:27], s56 offen lds
    s_branch ex_5
ex_4:
    s_cmp_eq_u32 s3, 2
    s_cbranch_scc1 ex_6
    s_mov_b64 exec, 1
    buffer_store_dword v30, v14, s[32:35], 0 offen sc1
    s_mov_b64 exec, -1
    s_branch ex_5
ex_6:
    s_mov_b64 exec, 1
    buffer_load_dword v31, v16, s[24:27], s56 offen
    s_mov_b64 exec, -1
ex_5:
    s_add_u32 m0, s100, 0
    s_nop 0
    buffer_load_dwordx4 v16, s[24:27], s56 offen lds
    s_add_u32 m0, s100, 4096
    s_nop 0
    buffer_load_dwordx4 v17, s[24:27], s56 offen lds
    s_add_u32 m0, s100, 8192
    s_nop 0
    buffer_load_dwordx4 v18, s[24:27], s56 offen lds
    s_add_u32 m0, s100, 12288
    s_nop 0
    buffer_load_dwordx4 v19, s[24:27], s56 offen lds
    s_add_u32 m0, s4, 18432
    s_nop 0
    buffer_load_dwordx4 v21, s[28:31], s57 offen lds
    s_add_u32 m0, s5, 18432
    s_nop 0
    buffer_load_dwordx4 v22, s[28:31], s57 offen lds
    s_add_u32 m0, s6, 18432
    s_nop 0
    buffer_load_dwordx4 v23, s[28:31], s57 offen lds
    s_add_u32 m0, s7, 18432
    s_nop 0
    buffer_load_dwordx4 v24, s[28:31], s57 offen lds
    s_add_u32 m0, s10, 18432
    s_nop 0
    buffer_load_dwordx4 v25, s[28:31], s57 offen lds
    s_add_u32 m0, s11, 18432
    s_nop 0
    buffer_load_dwordx4 v26, s[28:31], s57 offen lds
    s_waitcnt vmcnt(11)
    s_barrier
    s_add_u32 s56, s98, 2
    s_and_b32 s56, s56, 7
    s_mul_i32 s57, s56, 196608
    s_lshl_b32 s56, s56, 7
    s_cmp_ge_u32 s3, 2
    s_cbranch_scc1 ex_7
    s_add_u32 m0, s100, 102400
    s_nop 0
    buffer_load_dwordx4 v20, s[24:27], s56 offen lds
    s_branch ex_8
ex_7:
    s_mov_b64 exec, 1
    buffer_load_dword v31, v16, s[24:27], s56 offen
    s_mov_b64 exec, -1
ex_8:
    s_add_u32 m0, s100, 86016
    s_nop 0
    buffer_load_dwordx4 v16, s[24:27], s56 offen lds
    s_add_u32 m0, s100, 90112
    s_nop 0
    buffer_load_dwordx4 v17, s[24:27], s56 offen lds
    s_add_u32 m0, s100, 94208
    s_nop 0
    buffer_load_dwordx4 v18, s[24:27], s56 offen lds
    s_add_u32 m0, s100, 98304
    s_nop 0
    buffer_load_dwordx4 v19, s[24:27], s56 offen lds
    s_add_u32 m0, s4, 104448
    s_nop 0
    buffer_load_dwordx4 v21, s[28:31], s57 offen lds
    s_add_u32 m0, s5, 104448
    s_nop 0
    buffer_load_dwordx4 v22, s[28:31], s57 offen lds
    s_add_u32 m0, s6, 104448
    s_nop 0
    buffer_load_dwordx4 v23, s[28:31], s57 offen lds
    s_add_u32 m0, s7, 104448
    s_nop 0
    buffer_load_dwordx4 v24, s[28:31], s57 offen lds
    s_add_u32 m0, s10, 104448
    s_nop 0
    buffer_load_dwordx4 v25, s[28:31], s57 offen lds
    s_add_u32 m0, s11, 104448
    s_nop 0
    buffer_load_dwordx4 v26, s[28:31], s57 offen lds
    s_waitcnt vmcnt(11)
    s_barrier
    s_add_u32 s56, s98, 3
    s_and_b32 s56, s56, 7
    s_mul_i32 s57, s56, 196608
    s_lshl_b32 s56, s56, 7
    s_cmp_ge_u32 s3, 2
    s_cbranch_scc1 ex_9
    s_add_u32 m0, s100, 59392
    s_nop 0
    buffer_load_dwordx4 v20, s[24:27], s56 offen lds
    s_branch ex_10
ex_9:
    s_cmp_eq_u32 s3, 2
    s_cbranch_scc1 ex_11
    s_mov_b64 exec, 1
    buffer_atomic_add v15, v13, s[48:51], 0 offen sc1
    s_mov_b64 exec, -1
    s_branch ex_10
ex_11:
    s_mov_b64 exec, 1
    buffer_load_dword v31, v16, s[24:27], s56 offen
    s_mov_b64 exec, -1
ex_10:
    s_add_u32 m0, s100, 43008
    s_nop 0
    buffer_load_dwordx4 v16, s[24:27], s56 offen lds
    s_add_u32 m0, s100, 47104
    s_nop 0
    buffer_load_dwordx4 v17, s[24:27], s56 offen lds
    s_add_u32 m0, s100, 51200
    s_nop 0
    buffer_load_dwordx4 v18, s[24:27], s56 offen lds
    s_add_u32 m0, s100, 55296
    s_nop 0
    buffer_load_dwordx4 v19, s[24:27], s56 offen lds
    s_add_u32 m0, s4, 61440
    s_nop 0
    buffer_load_dwordx4 v21, s[28:31], s57 offen lds
    s_add_u32 m0, s5, 61440
    s_nop 0
    buffer_load_dwordx4 v22, s[28:31], s57 offen lds
    s_add_u32 m0, s6, 61440
    s_nop 0
    buffer_load_dwordx4 v23, s[28:31], s57 offen lds
    s_add_u32 m0, s7, 61440
    s_nop 0
    buffer_load_dwordx4 v24, s[28:31], s57 offen lds
    s_add_u32 m0, s10, 61440
    s_nop 0
    buffer_load_dwordx4 v25, s[28:31], s57 offen lds
    s_add_u32 m0, s11, 61440
    s_nop 0
    buffer_load_dwordx4 v26, s[28:31], s57 offen lds
    s_add_u32 m0, s4, 129024
    s_nop 0
    buffer_load_dwordx4 v21, s[28:31], s17 offen lds
    s_add_u32 m0, s5, 129024
    s_nop 0
    buffer_load_dwordx4 v22, s[28:31], s17 offen lds
    s_waitcnt vmcnt(13)
    s_barrier
    s_add_u32 s56, s98, 4
    s_and_b32 s56, s56, 7
    s_mul_i32 s57, s56, 196608
    s_lshl_b32 s56, s56, 7
    s_cmp_ge_u32 s3, 2
    s_cbranch_scc1 ex_12
    s_add_u32 m0, s100, 16384
    s_nop 0
    buffer_load_dwordx4 v20, s[24:27], s56 offen lds
    s_branch ex_13
ex_12:
    s_mov_b64 exec, 1
    buffer_load_dword v31, v16, s[24:27], s56 offen
    s_mov_b64 exec, -1
ex_13:
    s_add_u32 m0, s100, 0
    s_nop 0
    buffer_load_dwordx4 v16, s[24:27], s56 offen lds
    s_add_u32 m0, s100, 4096
    s_nop 0
    buffer_load_dwordx4 v17, s[24:27], s56 offen lds
    s_add_u32 m0, s100, 8192
    s_nop 0
    buffer_load_dwordx4 v18, s[24:27], s56 offen lds
    s_add_u32 m0, s100, 12288
    s_nop 0
    buffer_load_dwordx4 v19, s[24:27], s56 offen lds
    s_add_u32 m0, s4, 18432
    s_nop 0
    buffer_load_dwordx4 v21, s[28:31], s57 offen lds
    s_add_u32 m0, s5, 18432
    s_nop 0
    buffer_load_dwordx4 v22, s[28:31], s57 offen lds
    s_add_u32 m0, s6, 18432
    s_nop 0
    buffer_load_dwordx4 v23, s[28:31], s57 offen lds
    s_add_u32 m0, s7, 18432
    s_nop 0
    buffer_load_dwordx4 v24, s[28:31], s57 offen lds
    s_add_u32 m0, s10, 18432
    s_nop 0
    buffer_load_dwordx4 v25, s[28:31], s57 offen lds
    s_add_u32 m0, s11, 18432
    s_nop 0
    buffer_load_dwordx4 v26, s[28:31], s57 offen lds
    s_add_u32 m0, s6, 129024
    s_nop 0
    buffer_load_dwordx4 v23, s[28:31], s17 offen lds
    s_add_u32 m0, s7, 129024
    s_nop 0
    buffer_load_dwordx4 v24, s[28:31], s17 offen lds
    s_waitcnt vmcnt(15)
    s_barrier
    s_add_u32 s56, s98, 5
    s_and_b32 s56, s56, 7
    s_mul_i32 s57, s56, 196608
    s_lshl_b32 s56, s56, 7
    s_cmp_ge_u32 s3, 2
    s_cbranch_scc1 ex_14
    s_add_u32 m0, s100, 102400
    s_nop 0
    buffer_load_dwordx4 v20, s[24:27], s56 offen lds
    s_branch ex_15
ex_14:
    s_mov_b64 exec, 1
    buffer_load_dword v31, v16, s[24:27], s56 offen
    s_mov_b64 exec, -1
ex_15:
    s_add_u32 m0, s100, 86016
    s_nop 0
    buffer_load_dwordx4 v16, s[24:27], s56 offen lds
    s_add_u32 m0, s100, 90112
    s_nop 0
    buffer_load_dwordx4 v17, s[24:27], s56 offen lds
    s_add_u32 m0, s100, 94208
    s_nop 0
    buffer_load_dwordx4 v18, s[24:27], s56 offen lds
    s_add_u32 m0, s100, 98304
    s_nop 0
    buffer_load_dwordx4 v19, s[24:27], s56 offen lds
    s_add_u32 m0, s4, 104448
    s_nop 0
    buffer_load_dwordx4 v21, s[28:31], s57 offen lds
    s_add_u32 m0, s5, 104448
    s_nop 0
    buffer_load_dwordx4 v22, s[28:31], s57 offen lds
    s_add_u32 m0, s6, 104448
    s_nop 0
    buffer_load_dwordx4 v23, s[28:31], s57 offen lds
    s_add_u32 m0, s7, 104448
    s_nop 0
    buffer_load_dwordx4 v24, s[28:31], s57 offen lds
    s_add_u32 m0, s10, 104448
    s_nop 0
    buffer_load_dwordx4 v25, s[28:31], s57 offen lds
    s_add_u32 m0, s11, 104448
    s_nop 0
    buffer_load_dwordx4 v26, s[28:31], s57 offen lds
    s_add_u32 m0, s10, 129024
    s_nop 0
    buffer_load_dwordx4 v25, s[28:31], s17 offen lds
    s_add_u32 m0, s11, 129024
    s_nop 0
    buffer_load_dwordx4 v26, s[28:31], s17 offen lds
    s_waitcnt vmcnt(15)
    s_barrier
    s_add_u32 s56, s98, 6
    s_and_b32 s56, s56, 7
    s_mul_i32 s57, s56, 196608
    s_lshl_b32 s56, s56, 7
    s_cmp_ge_u32 s3, 2
    s_cbranch_scc1 ex_16
    s_add_u32 m0, s100, 59392
    s_nop 0
    buffer_load_dwordx4 v20, s[24:27], s56 offen lds
    s_branch ex_17
ex_16:
    s_mov_b64 exec, 1
    buffer_load_dword v31, v16, s[24:27], s56 offen
    s_mov_b64 exec, -1
ex_17:
    s_add_u32 m0, s100, 43008
    s_nop 0
    buffer_load_dwordx4 v16, s[24:27], s56 offen lds
    s_add_u32 m0, s100, 47104
    s_nop 0
    buffer_load_dwordx4 v17, s[24:27], s56 offen lds
    s_add_u32 m0, s100, 51200
    s_nop 0
    buffer_load_dwordx4 v18, s[24:27], s56 offen lds
    s_add_u32 m0, s100, 55296
    s_nop 0
    buffer_load_dwordx4 v19, s[24:27], s56 offen lds
    s_add_u32 m0, s4, 61440
    s_nop 0
    buffer_load_dwordx4 v21, s[28:31], s57 offen lds
    s_add_u32 m0, s5, 61440
    s_nop 0
    buffer_load_dwordx4 v22, s[28:31], s57 offen lds
    s_add_u32 m0, s6, 61440
    s_nop 0
    buffer_load_dwordx4 v23, s[28:31], s57 offen lds
    s_add_u32 m0, s7, 61440
    s_nop 0
    buffer_load_dwordx4 v24, s[28:31], s57 offen lds
    s_add_u32 m0, s10, 61440
    s_nop 0
    buffer_load_dwordx4 v25, s[28:31], s57 offen lds
    s_add_u32 m0, s11, 61440
    s_nop 0
    buffer_load_dwordx4 v26, s[28:31], s57 offen lds
    s_add_u32 m0, s100, 153600
    s_nop 0
    buffer_load_dwordx4 v16, s[24:27], s16 offen lds
    s_add_u32 m0, s100, 157696
    s_nop 0
    buffer_load_dwordx4 v17, s[24:27], s16 offen lds
    s_waitcnt vmcnt(15)
    s_barrier
    s_add_u32 s56, s98, 7
    s_and_b32 s56, s56, 7
    s_mul_i32 s57, s56, 196608
    s_lshl_b32 s56, s56, 7
    s_cmp_ge_u32 s3, 2
    s_cbranch_scc1 ex_18
    s_add_u32 m0, s100, 8192
    s_nop 0
    buffer_load_dwordx4 v20, s[24:27], s56 offen lds
    s_branch ex_19
ex_18:
    s_mov_b64 exec, 1
    buffer_load_dword v31, v16, s[24:27], s56 offen
    s_mov_b64 exec, -1
ex_19:
    s_add_u32 m0, s100, 0
    s_nop 0
    buffer_load_dwordx4 v18, s[24:27], s56 offen lds
    s_add_u32 m0, s100, 4096
    s_nop 0
    buffer_load_dwordx4 v19, s[24:27], s56 offen lds
    s_bfe_u32 s56, s99, 262144
    s_add_u32 m0, s100, 10240
    s_lshl_b32 s56, s56, 15
    buffer_load_dwordx4 v27, s[44:47], s56 offen lds
    s_bfe_u32 s56, s99, 262148
    s_add_u32 m0, s100, 14336
    s_lshl_b32 s56, s56, 15
    buffer_load_dwordx4 v27, s[44:47], s56 offen lds
    s_bfe_u32 s56, s99, 262152
    s_add_u32 m0, s100, 18432
    s_lshl_b32 s56, s56, 15
    buffer_load_dwordx4 v27, s[44:47], s56 offen lds
    s_bfe_u32 s56, s99, 262156
    s_add_u32 m0, s100, 22528
    s_lshl_b32 s56, s56, 15
    buffer_load_dwordx4 v27, s[44:47], s56 offen lds
    s_bfe_u32 s56, s99, 262160
    s_add_u32 m0, s100, 26624
    s_lshl_b32 s56, s56, 15
    buffer_load_dwordx4 v27, s[44:47], s56 offen lds
    s_bfe_u32 s56, s99, 262164
    s_add_u32 m0, s100, 30720
    s_lshl_b32 s56, s56, 15
    buffer_load_dwordx4 v27, s[44:47], s56 offen lds
    s_bfe_u32 s56, s99, 262168
    s_add_u32 m0, s100, 34816
    s_lshl_b32 s56, s56, 15
    buffer_load_dwordx4 v27, s[44:47], s56 offen lds
    s_bfe_u32 s56, s99, 262172
    s_add_u32 m0, s100, 38912
    s_lshl_b32 s56, s56, 15
    buffer_load_dwordx4 v27, s[44:47], s56 offen lds
    s_waitcnt vmcnt(13)
    s_barrier
    s_waitcnt vmcnt(8)
    s_barrier
    s_bfe_u32 s56, s99, 262156
    s_add_u32 m0, s100, 88064
    s_lshl_b32 s56, s56, 15
    buffer_load_dwordx4 v27, s[40:43], s56 offen lds
    s_bfe_u32 s56, s99, 262160
    s_add_u32 m0, s100, 92160
    s_lshl_b32 s56, s56, 15
    buffer_load_dwordx4 v27, s[40:43], s56 offen lds
    s_bfe_u32 s56, s99, 262164
    s_add_u32 m0, s100, 96256
    s_lshl_b32 s56, s56, 15
    buffer_load_dwordx4 v27, s[40:43], s56 offen lds
    s_bfe_u32 s56, s99, 262168
    s_add_u32 m0, s100, 100352
    s_lshl_b32 s56, s56, 15
    buffer_load_dwordx4 v27, s[40:43], s56 offen lds
    s_bfe_u32 s56, s99, 262172
    s_add_u32 m0, s100, 104448
    s_lshl_b32 s56, s56, 15
    buffer_load_dwordx4 v27, s[40:43], s56 offen lds
    s_bfe_u32 s56, s12, 262144
    s_add_u32 m0, s100, 108544
    s_lshl_b32 s56, s56, 15
    buffer_load_dwordx4 v27, s[40:43], s56 offen lds
    s_bfe_u32 s56, s12, 262148
    s_add_u32 m0, s100, 112640
    s_lshl_b32 s56, s56, 15
    buffer_load_dwordx4 v27, s[40:43], s56 offen lds
    s_bfe_u32 s56, s12, 262152
    s_add_u32 m0, s100, 116736
    s_lshl_b32 s56, s56, 15
    buffer_load_dwordx4 v27, s[40:43], s56 offen lds
    s_bfe_u32 s56, s12, 262156
    s_add_u32 m0, s100, 120832
    s_lshl_b32 s56, s56, 15
    buffer_load_dwordx4 v27, s[40:43], s56 offen lds
    s_bfe_u32 s56, s12, 262160
    s_add_u32 m0, s100, 124928
    s_lshl_b32 s56, s56, 15
    buffer_load_dwordx4 v27, s[40:43], s56 offen lds
    s_barrier
    s_cmp_eq_u32 s3, 0
    s_cbranch_scc0 L_NOI0
    buffer_load_dword v30, v28, s[48:51], 0 offen sc1
L_NOI0:
    s_bfe_u32 s56, s12, 262144
    s_add_u32 m0, s100, 43008
    s_lshl_b32 s56, s56, 15
    buffer_load_dwordx4 v27, s[44:47], s56 offen lds
    s_bfe_u32 s56, s12, 262148
    s_add_u32 m0, s100, 47104
    s_lshl_b32 s56, s56, 15
    buffer_load_dwordx4 v27, s[44:47], s56 offen lds
    s_bfe_u32 s56, s12, 262152
    s_add_u32 m0, s100, 51200
    s_lshl_b32 s56, s56, 15
    buffer_load_dwordx4 v27, s[44:47], s56 offen lds
    s_bfe_u32 s56, s12, 262156
    s_add_u32 m0, s100, 55296
    s_lshl_b32 s56, s56, 15
    buffer_load_dwordx4 v27, s[44:47], s56 offen lds
    s_bfe_u32 s56, s12, 262160
    s_add_u32 m0, s100, 59392
    s_lshl_b32 s56, s56, 15
    buffer_load_dwordx4 v27, s[44:47], s56 offen lds
    s_bfe_u32 s56, s12, 262164
    s_add_u32 m0, s100, 63488
    s_lshl_b32 s56, s56, 15
    buffer_load_dwordx4 v27, s[44:47], s56 offen lds
    s_bfe_u32 s56, s12, 262168
    s_add_u32 m0, s100, 67584
    s_lshl_b32 s56, s56, 15
    buffer_load_dwordx4 v27, s[44:47], s56 offen lds
    s_bfe_u32 s56, s12, 262172
    s_add_u32 m0, s100, 71680
    s_lshl_b32 s56, s56, 15
    buffer_load_dwordx4 v27, s[44:47], s56 offen lds
    s_bfe_u32 s56, s99, 262144
    s_add_u32 m0, s100, 75776
    s_lshl_b32 s56, s56, 15
    buffer_load_dwordx4 v27, s[40:43], s56 offen lds
    s_bfe_u32 s56, s99, 262148
    s_add_u32 m0, s100, 79872
    s_lshl_b32 s56, s56, 15
    buffer_load_dwordx4 v27, s[40:43], s56 offen lds
    s_bfe_u32 s56, s99, 262152
    s_add_u32 m0, s100, 83968
    s_lshl_b32 s56, s56, 15
    buffer_load_dwordx4 v27, s[40:43], s56 offen lds
    s_bfe_u32 s56, s12, 262164
    s_add_u32 m0, s100, 129024
    s_lshl_b32 s56, s56, 15
    buffer_load_dwordx4 v27, s[40:43], s56 offen lds
    s_bfe_u32 s56, s12, 262168
    s_add_u32 m0, s100, 133120
    s_lshl_b32 s56, s56, 15
    buffer_load_dwordx4 v27, s[40:43], s56 offen lds
    s_bfe_u32 s56, s12, 262172
    s_add_u32 m0, s100, 137216
    s_lshl_b32 s56, s56, 15
    buffer_load_dwordx4 v27, s[40:43], s56 offen lds
    s_cmp_eq_u32 s3, 0
    s_cbranch_scc0 L_NOINIT
    s_mov_b32 s58, 262144
    s_waitcnt vmcnt(14)
L_INIT:
    v_cmp_gt_u32 vcc, 16, v30
    s_sub_u32 s58, s58, 1
    s_cbranch_vccz L_INITOK
    s_cmp_eq_u32 s58, 0
    s_cbranch_scc1 L_INITOK
    buffer_load_dword v30, v28, s[48:51], 0 offen sc1
    s_waitcnt vmcnt(0)
    s_branch L_INIT
L_INITOK:
L_NOINIT:
    s_lshr_b32 s48, s3, 2
    s_and_b32 s49, s3, 3
    s_xor_b32 s57, s48, s96
    s_and_b32 s50, s57, 1
    s_mov_b32 s36, s18
    s_mov_b32 s37, s19
    s_mov_b32 s38, 0x200000
    s_mov_b32 s39, 0x20000
    s_lshr_b32 s56, s13, 1
    s_lshl3_add_u32 s56, s48, s56
    s_lshl_b32 s54, 15, s56
    s_xor_b32 s56, s56, 4
    s_lshl_b32 s55, 15, s56
    s_bfe_u32 s56, s99, 262144
    s_lshl_b32 s4, s56, 10
    s_xor_b32 s12, s4, 8192
    s_bfe_u32 s56, s99, 262148
    s_lshl_b32 s5, s56, 10
    s_xor_b32 s13, s5, 8192
    s_bfe_u32 s56, s99, 262152
    s_lshl_b32 s6, s56, 10
    s_xor_b32 s14, s6, 8192
    s_bfe_u32 s56, s99, 262156
    s_lshl_b32 s7, s56, 10
    s_xor_b32 s15, s7, 8192
    s_bfe_u32 s56, s99, 262160
    s_lshl_b32 s8, s56, 10
    s_xor_b32 s16, s8, 8192
    s_bfe_u32 s56, s99, 262164
    s_lshl_b32 s9, s56, 10
    s_xor_b32 s17, s9, 8192
    s_bfe_u32 s56, s99, 262168
    s_lshl_b32 s10, s56, 10
    s_xor_b32 s18, s10, 8192
    s_bfe_u32 s56, s99, 262172
    s_lshl_b32 s11, s56, 10
    s_xor_b32 s19, s11, 8192
    v_lshrrev_b32 v1, 4, v0
    v_and_b32 v2, 15, v0
    v_lshrrev_b32 v3, 2, v2
    v_lshl_add_u32 v15, v1, 3, v3
    v_lshlrev_b32 v15, 7, v15
    v_lshrrev_b32 v3, 1, v3
    v_and_b32 v246, 1, v1
    v_lshl_or_b32 v3, v246, 1, v3
    v_and_b32 v245, 3, v2
    v_lshl_add_u32 v15, v245, 3, v15
    s_xor_b32 s57, s50, 1
    s_lshl_b32 s57, s57, 16
    s_add_u32 s57, s57, 10240
    v_add_u32 v15, s57, v15
    s_lshl_b32 s57, s48, 1
    s_xor_b32 s57, s57, 2
    v_xor_b32 v3, s57, v3
    v_lshl_add_u32 v248, v3, 5, v15
    v_xor_b32 v245, 1, v3
    v_lshl_add_u32 v249, v245, 5, v15
    v_xor_b32 v245, 2, v3
    v_lshl_add_u32 v250, v245, 5, v15
    v_xor_b32 v245, 3, v3
    v_lshl_add_u32 v251, v245, 5, v15
    s_lshl2_add_u32 s56, s96, s49
    s_lshl1_add_u32 s57, s56, s48
    s_lshl_b32 s57, s57, 14
    s_nop 0
    s_nop 0
    s_xor_b32 s57, s57, 0
    v_lshl_add_u32 v245, v0, 4, s57
    v_lshl_add_u32 v3, s56, 4, v2
    s_lshl1_add_u32 s57, s97, s48
    s_lshl_b32 s57, s57, 6
    v_lshl_add_u32 v247, v3, 10, s57
    v_lshl_add_u32 v247, v246, 5, v247
    v_lshrrev_b32 v1, 1, v1
    v_lshl_add_u32 v247, v1, 4, v247
    v_lshlrev_b32 v246, 2, v3
    v_add_u32 v246, 8388608, v246
    s_lshl_b32 s57, s3, 11
    v_lshl_add_u32 v252, v0, 4, s57
    v_xor_b32 v253, 8192, v252
    v_add_u32 v252, 141312, v252
    v_add_u32 v253, 141312, v253
    s_lshl_b32 s57, s49, 8
    s_add_u32 s57, s57, 157696
    v_lshl_add_u32 v254, v0, 2, s57
    s_lshr_b32 s56, s96, 1
    s_lshl_b32 s56, s56, 8
    s_add_u32 s56, s56, 9437184
    v_lshl_add_u32 v255, v2, 2, s56
    v_mov_b32 v1, v245
    v_mov_b32 v3, v246
    v_mov_b32 v8, v247
    v_mov_b32 v4, v248
    v_mov_b32 v5, v249
    v_mov_b32 v6, v250
    v_mov_b32 v7, v251
    v_mov_b32 v9, v252
    v_mov_b32 v0, v255
    v_mov_b32 v14, v253
    v_mov_b32 v13, v254
    v_mov_b32 v12, 162816
    v_mov_b32 v15, 1
    s_mov_b32 s58, 262144
    s_mov_b64 exec, 1
    s_waitcnt vmcnt(0)
    ds_add_u32 v12, v15 offset:4
    s_mov_b64 exec, -1
    ds_read_b32 v2, v12 offset:4
    s_branch K_P2
.fill 36, 4, 0xbf800000
K_CONS:
    s_sub_u32 s101, s3, 4
    s_lshl_b32 s56, s52, 6
    s_lshl2_add_u32 s56, s53, s56
    s_add_u32 s56, s56, s101
    v_lshrrev_b32 v3, 5, v0
    v_lshl_add_u32 v11, s56, 1, v3
    v_and_b32 v1, 127, v11
    v_add_u32 v1, 16, v1
    v_bfe_u32 v2, v1, 1, 3
    v_bfe_u32 v4, v0, 2, 3
    v_xor_b32 v2, v2, v4
    v_lshlrev_b32 v2, 4, v2
    v_lshl_add_u32 v2, v1, 7, v2
    v_and_b32 v4, 3, v0
    v_lshl_add_u32 v236, v4, 2, v2
    v_add_u32 v237, 43008, v236
    v_and_b32 v4, 31, v0
    v_lshlrev_b32 v4, 2, v4
    v_add_u32 v238, 161792, v4
    v_mov_b32 v239, v238
    v_mov_b32 v240, 0
    v_mov_b32 v241, 0
    s_add_u32 s56, s53, s52
    s_mul_i32 s57, s56, 86
    s_lshr_b32 s57, s57, 8
    s_mul_i32 s57, s57, 3
    s_sub_u32 s56, s56, s57
    s_lshl_b32 s56, s56, 2
    s_lshr_b32 s56, 0x630, s56
    s_and_b32 s98, s56, 15
    s_and_b32 s98, s98, 7
    v_lshl_add_u32 v239, s98, 7, v238
    s_cmp_lt_u32 s53, 6
    s_movk_i32 s100, -8192
    s_cselect_b32 s100, 153600, s100
    s_waitcnt lgkmcnt(0)
    s_mov_b32 s32, s22
    s_mov_b32 s33, s23
    s_mov_b32 s34, 268435456
    s_mov_b32 s35, 0x20000
    s_lshr_b32 s57, s2, 3
    s_and_b32 s96, s57, 3
    s_lshr_b32 s97, s57, 2
    s_lshr_b32 s56, s96, 1
    s_lshr_b32 s13, s97, 2
    s_xor_b32 s13, s13, s56
    s_and_b32 s56, s97, 3
    s_lshl_b32 s56, s56, 3
    s_mov_b32 s58, 0x76543210
    s_mov_b32 s59, s58
    s_lshr_b64 s[58:59], s[58:59], s56
    s_mul_i32 s59, s13, 0x88888888
    s_or_b32 s99, s58, s59
    s_lshl_b32 s13, s13, 3
    s_andn2_b32 s56, 1, s2
    s_lshr_b32 s57, s2, 1
    s_and_b32 s57, s57, 3
    s_lshl2_add_u32 s56, s56, s57
    s_lshl2_add_u32 s96, s56, s96
    s_lshl_b32 s56, s52, 8
    s_lshl2_add_u32 s56, s53, s56
    s_add_u32 s56, s56, 9437184
    v_mov_b32 v14, s56
    v_mov_b32 v2, 0
    v_mov_b32 v12, 162816
    v_lshlrev_b32 v11, 2, v11
    v_add_u32 v11, 8388608, v11
    v_and_b32 v3, 31, v0
    v_lshl_or_b32 v11, v3, 28, v11
    v_lshrrev_b32 v3, 4, v3
    v_lshl_or_b32 v11, v3, 28, v11
    v_mov_b32 v3, 0
    ds_write_b64 v12, v[2:3]
    ds_write_b64 v12, v[2:3] offset:8
    v_lshrrev_b32 v1, 4, v0
    v_and_b32 v2, 15, v0
    v_lshrrev_b32 v3, 1, v2
    v_xor_b32 v3, v1, v3
    v_lshlrev_b32 v3, 4, v3
    v_lshl_add_u32 v7, v2, 7, v3
    v_xor_b32 v8, 64, v7
    v_lshrrev_b32 v3, 2, v2
    v_lshl_add_u32 v9, v1, 3, v3
    v_lshlrev_b32 v9, 7, v9
    v_lshrrev_b32 v3, 1, v3
    v_and_b32 v15, 1, v1
    v_lshl_or_b32 v3, v15, 1, v3
    v_xor_b32 v3, s101, v3
    v_lshl_add_u32 v9, v3, 5, v9
    v_and_b32 v3, 3, v2
    v_lshl_add_u32 v9, v3, 3, v9
    v_add_u32 v9, 18432, v9
    v_add_u32 v4, 43008, v7
    v_add_u32 v5, 43008, v8
    v_add_u32 v6, 43008, v9
    s_lshl2_add_u32 s56, s55, s101
    s_lshl_b32 s57, s52, 18
    s_lshl_b32 s58, s54, 14
    s_add_u32 s57, s57, s58
    s_lshr_b32 s58, s56, 1
    s_lshl_b32 s58, s58, 10
    s_add_u32 s57, s57, s58
    s_and_b32 s58, s56, 1
    s_lshl_b32 s58, s58, 9
    s_add_u32 s57, s57, s58
    v_and_b32 v3, 1, v1
    v_lshlrev_b32 v13, 15, v3
    v_lshrrev_b32 v3, 1, v1
    v_lshl_add_u32 v13, v3, 8, v13
    v_lshl_add_u32 v13, v2, 4, v13
    s_xor_b32 s57, s57, 0
    v_add_u32 v13, s57, v13
    s_mov_b32 s58, 4048155338
    v_lshlrev_b32 v3, 2, v1
    v_sub_u32 v3, v2, v3
    v_mov_b32 v15, s58
    v_mov_b32 v18, 0x0c0c0c0c
    v_mov_b32 v228, v18
    v_mov_b32 v229, v18
    v_mov_b32 v230, v18
    v_mov_b32 v231, v18
    v_subrev_u32 v16, 0, v3
    v_and_b32 v17, 1, v16
    v_cmp_eq_u32 s[40:41], 0, v17
    v_cmp_le_i32 s[42:43], 0, v16
    v_mov_b32 v18, 202113280
    s_nop 0
    s_and_b64 s[44:45], s[40:41], s[42:43]
    s_andn2_b64 s[46:47], s[40:41], s[42:43]
    v_cndmask_b32 v216, v15, 0, s[44:45]
    v_cndmask_b32 v220, v15, 0, s[46:47]
    v_cndmask_b32 v228, v228, v18, s[46:47]
    v_cndmask_b32 v230, v230, v18, s[44:45]
    v_subrev_u32 v16, 1, v3
    v_and_b32 v17, 1, v16
    v_cmp_eq_u32 s[40:41], 0, v17
    v_cmp_le_i32 s[42:43], 0, v16
    v_mov_b32 v18, 16780300
    s_nop 0
    s_and_b64 s[44:45], s[40:41], s[42:43]
    s_andn2_b64 s[46:47], s[40:41], s[42:43]
    v_cndmask_b32 v217, v15, 0, s[44:45]
    v_cndmask_b32 v221, v15, 0, s[46:47]
    v_cndmask_b32 v228, v228, v18, s[46:47]
    v_cndmask_b32 v230, v230, v18, s[44:45]
    v_subrev_u32 v16, 2, v3
    v_and_b32 v17, 1, v16
    v_cmp_eq_u32 s[40:41], 0, v17
    v_cmp_le_i32 s[42:43], 0, v16
    v_mov_b32 v18, 202113794
    s_nop 0
    s_and_b64 s[44:45], s[40:41], s[42:43]
    s_andn2_b64 s[46:47], s[40:41], s[42:43]
    v_cndmask_b32 v218, v15, 0, s[44:45]
    v_cndmask_b32 v222, v15, 0, s[46:47]
    v_cndmask_b32 v229, v229, v18, s[46:47]
    v_cndmask_b32 v231, v231, v18, s[44:45]
    v_subrev_u32 v16, 3, v3
    v_and_b32 v17, 1, v16
    v_cmp_eq_u32 s[40:41], 0, v17
    v_cmp_le_i32 s[42:43], 0, v16
    v_mov_b32 v18, 50465804
    s_nop 0
    s_and_b64 s[44:45], s[40:41], s[42:43]
    s_andn2_b64 s[46:47], s[40:41], s[42:43]
    v_cndmask_b32 v219, v15, 0, s[44:45]
    v_cndmask_b32 v223, v15, 0, s[46:47]
    v_cndmask_b32 v229, v229, v18, s[46:47]
    v_cndmask_b32 v231, v231, v18, s[44:45]
    s_cmp_eq_u32 s52, 0
    s_cselect_b64 s[44:45], -1, 0
    v_cndmask_b32 v224, v220, v15, s[44:45]
    v_mov_b32 v232, 0x3f803f80
    v_cndmask_b32 v225, v221, v15, s[44:45]
    v_mov_b32 v233, 0x3f803f80
    v_cndmask_b32 v226, v222, v15, s[44:45]
    v_mov_b32 v234, 0x3f803f80
    v_cndmask_b32 v227, v223, v15, s[44:45]
    v_mov_b32 v235, 0x3f803f80
    s_lshr_b32 s48, s3, 2
    s_and_b32 s49, s3, 3
    s_xor_b32 s57, s48, s96
    s_and_b32 s50, s57, 1
    s_mov_b32 s36, s18
    s_mov_b32 s37, s19
    s_mov_b32 s38, 0x200000
    s_mov_b32 s39, 0x20000
    s_lshr_b32 s56, s13, 1
    s_lshl3_add_u32 s56, s48, s56
    s_lshl_b32 s54, 15, s56
    s_xor_b32 s56, s56, 4
    s_lshl_b32 s55, 15, s56
    s_bfe_u32 s56, s99, 262144
    s_lshl_b32 s4, s56, 10
    s_xor_b32 s12, s4, 8192
    s_bfe_u32 s56, s99, 262148
    s_lshl_b32 s5, s56, 10
    s_xor_b32 s13, s5, 8192
    s_bfe_u32 s56, s99, 262152
    s_lshl_b32 s6, s56, 10
    s_xor_b32 s14, s6, 8192
    s_bfe_u32 s56, s99, 262156
    s_lshl_b32 s7, s56, 10
    s_xor_b32 s15, s7, 8192
    s_bfe_u32 s56, s99, 262160
    s_lshl_b32 s8, s56, 10
    s_xor_b32 s16, s8, 8192
    s_bfe_u32 s56, s99, 262164
    s_lshl_b32 s9, s56, 10
    s_xor_b32 s17, s9, 8192
    s_bfe_u32 s56, s99, 262168
    s_lshl_b32 s10, s56, 10
    s_xor_b32 s18, s10, 8192
    s_bfe_u32 s56, s99, 262172
    s_lshl_b32 s11, s56, 10
    s_xor_b32 s19, s11, 8192
    s_mov_b32 s40, 65536
    s_mov_b32 s41, 131072
    s_mov_b32 s42, 196608
    s_mov_b32 s43, 1052289595
    s_mov_b32 s44, 1052289595
    s_mov_b32 s45, 1052289595
    s_waitcnt lgkmcnt(0)
    s_barrier
    ds_read_b64_tr_b16 v[156:157], v6 offset:0
    ds_read_b64_tr_b16 v[158:159], v6 offset:512
    ds_read_b64_tr_b16 v[160:161], v6 offset:8192
    ds_read_b64_tr_b16 v[162:163], v6 offset:8704
    ds_read_b64_tr_b16 v[164:165], v6 offset:16384
    ds_read_b64_tr_b16 v[166:167], v6 offset:16896
    ds_read_b128 v[120:123], v4 offset:0
    ds_read_b128 v[124:127], v4 offset:2048
    ds_read_b128 v[128:131], v4 offset:4096
    ds_read_b128 v[132:135], v4 offset:6144
    ds_read_b128 v[136:139], v4 offset:8192
    ds_read_b128 v[140:143], v4 offset:10240
    ds_read_b128 v[144:147], v4 offset:12288
    ds_read_b128 v[148:151], v4 offset:14336
    ds_read_b128 v[152:155], v4 offset:16384
    s_waitcnt lgkmcnt(0)
    v_mfma_f32_16x16x32_bf16 v[48:51], v[160:163], v[120:123], 0
    ds_read_b64_tr_b16 v[204:205], v6 offset:4096
    v_mfma_f32_16x16x32_bf16 v[52:55], v[160:163], v[124:127], 0
    ds_read_b64_tr_b16 v[206:207], v6 offset:4608
    v_mfma_f32_16x16x32_bf16 v[16:19], v[156:159], v[124:127], 0
    ds_read_b64_tr_b16 v[208:209], v6 offset:12288
    v_mfma_f32_16x16x32_bf16 v[20:23], v[156:159], v[128:131], 0
    ds_read_b64_tr_b16 v[210:211], v6 offset:12800
    v_mfma_f32_16x16x32_bf16 v[56:59], v[160:163], v[128:131], 0
    ds_read_b64_tr_b16 v[212:213], v6 offset:20480
    v_mfma_f32_16x16x32_bf16 v[60:63], v[160:163], v[132:135], 0
    ds_read_b64_tr_b16 v[214:215], v6 offset:20992
    v_mfma_f32_16x16x32_bf16 v[24:27], v[156:159], v[132:135], 0
    ds_read_b128 v[168:171], v5 offset:0
    v_mfma_f32_16x16x32_bf16 v[28:31], v[156:159], v[136:139], 0
    ds_read_b128 v[172:175], v5 offset:2048
    v_mfma_f32_16x16x32_bf16 v[64:67], v[160:163], v[136:139], 0
    ds_read_b128 v[176:179], v5 offset:4096
    v_mfma_f32_16x16x32_bf16 v[68:71], v[160:163], v[140:143], 0
    ds_read_b128 v[180:183], v5 offset:6144
    v_mfma_f32_16x16x32_bf16 v[32:35], v[156:159], v[140:143], 0
    ds_read_b128 v[184:187], v5 offset:8192
    v_mfma_f32_16x16x32_bf16 v[36:39], v[156:159], v[144:147], 0
    ds_read_b128 v[188:191], v5 offset:10240
    v_mfma_f32_16x16x32_bf16 v[72:75], v[160:163], v[144:147], 0
    ds_read_b128 v[192:195], v5 offset:12288
    v_mfma_f32_16x16x32_bf16 v[76:79], v[160:163], v[148:151], 0
    ds_read_b128 v[196:199], v5 offset:14336
    v_mfma_f32_16x16x32_bf16 v[40:43], v[156:159], v[148:151], 0
    ds_read_b128 v[200:203], v5 offset:16384
    v_mfma_f32_16x16x32_bf16 v[44:47], v[156:159], v[152:155], 0
    ds_read_b32 v242, v237
    v_mfma_f32_16x16x32_bf16 v[80:83], v[160:163], v[152:155], 0
    ds_read_b32 v243, v239
    v_mfma_f32_16x16x32_bf16 v[84:87], v[120:123], v[164:167], 0
    v_add_u32 v4, 0, v7
    v_add_u32 v5, 0, v8
    v_mfma_f32_16x16x32_bf16 v[88:91], v[124:127], v[164:167], 0
    v_add_u32 v6, 0, v9
    s_add_u32 s98, s98, 1
    v_mfma_f32_16x16x32_bf16 v[92:95], v[128:131], v[164:167], 0
    s_cmp_gt_u32 s98, 7
    s_cselect_b32 s98, 0, s98
    v_mfma_f32_16x16x32_bf16 v[96:99], v[132:135], v[164:167], 0
    v_lshl_add_u32 v239, s98, 7, v238
    v_add_u32 v237, 0, v236
    v_mfma_f32_16x16x32_bf16 v[100:103], v[136:139], v[164:167], 0
    v_mfma_f32_16x16x32_bf16 v[104:107], v[140:143], v[164:167], 0
    v_mfma_f32_16x16x32_bf16 v[108:111], v[144:147], v[164:167], 0
    v_mfma_f32_16x16x32_bf16 v[112:115], v[148:151], v[164:167], 0
    v_mfma_f32_16x16x32_bf16 v[116:119], v[152:155], v[164:167], 0
    s_waitcnt lgkmcnt(0)
    v_mfma_f32_16x16x32_bf16 v[48:51], v[208:211], v[168:171], v[48:51]
    v_lshlrev_b32 v1, 16, v242
    v_and_b32 v2, 0xffff0000, v242
    v_mfma_f32_16x16x32_bf16 v[52:55], v[208:211], v[172:175], v[52:55]
    v_lshlrev_b32 v3, 16, v243
    v_and_b32 v15, 0xffff0000, v243
    v_mfma_f32_16x16x32_bf16 v[16:19], v[204:207], v[172:175], v[16:19]
    v_mul_f32 v1, v1, v3
    v_mul_f32 v2, v2, v15
    v_mfma_f32_16x16x32_bf16 v[20:23], v[204:207], v[176:179], v[20:23]
    v_cvt_pk_bf16_f32 v1, v1, v2
    v_lshlrev_b32 v3, 16, v1
    v_mfma_f32_16x16x32_bf16 v[56:59], v[208:211], v[176:179], v[56:59]
    v_and_b32 v15, 0xffff0000, v1
    v_add_f32 v240, v240, v3
    v_mfma_f32_16x16x32_bf16 v[60:63], v[208:211], v[180:183], v[60:63]
    v_add_f32 v241, v241, v15
    v_lshrrev_b32 v1, 4, v0
    v_mfma_f32_16x16x32_bf16 v[24:27], v[204:207], v[180:183], v[24:27]
    v_and_b32 v2, 15, v0
    v_lshrrev_b32 v3, 2, v2
    v_mfma_f32_16x16x32_bf16 v[28:31], v[204:207], v[184:187], v[28:31]
    v_lshl_add_u32 v15, v1, 3, v3
    v_lshlrev_b32 v15, 7, v15
    v_mfma_f32_16x16x32_bf16 v[64:67], v[208:211], v[184:187], v[64:67]
    v_lshrrev_b32 v3, 1, v3
    v_and_b32 v246, 1, v1
    v_mfma_f32_16x16x32_bf16 v[68:71], v[208:211], v[188:191], v[68:71]
    v_lshl_or_b32 v3, v246, 1, v3
    v_and_b32 v245, 3, v2
    v_mfma_f32_16x16x32_bf16 v[32:35], v[204:207], v[188:191], v[32:35]
    v_lshl_add_u32 v15, v245, 3, v15
    s_xor_b32 s57, s50, 1
    v_mfma_f32_16x16x32_bf16 v[36:39], v[204:207], v[192:195], v[36:39]
    s_lshl_b32 s57, s57, 16
    s_add_u32 s57, s57, 10240
    v_mfma_f32_16x16x32_bf16 v[72:75], v[208:211], v[192:195], v[72:75]
    v_add_u32 v15, s57, v15
    s_lshl_b32 s57, s48, 1
    v_mfma_f32_16x16x32_bf16 v[76:79], v[208:211], v[196:199], v[76:79]
    s_xor_b32 s57, s57, 2
    v_xor_b32 v3, s57, v3
    v_mfma_f32_16x16x32_bf16 v[40:43], v[204:207], v[196:199], v[40:43]
    v_lshl_add_u32 v248, v3, 5, v15
    v_xor_b32 v245, 1, v3
    v_mfma_f32_16x16x32_bf16 v[44:47], v[204:207], v[200:203], v[44:47]
    v_lshl_add_u32 v249, v245, 5, v15
    v_xor_b32 v245, 2, v3
    v_mfma_f32_16x16x32_bf16 v[80:83], v[208:211], v[200:203], v[80:83]
    v_lshl_add_u32 v250, v245, 5, v15
    v_xor_b32 v245, 3, v3
    v_mfma_f32_16x16x32_bf16 v[84:87], v[168:171], v[212:215], v[84:87]
    v_lshl_add_u32 v251, v245, 5, v15
    s_lshl2_add_u32 s56, s96, s49
    v_mfma_f32_16x16x32_bf16 v[88:91], v[172:175], v[212:215], v[88:91]
    s_lshl1_add_u32 s57, s56, s48
    s_lshl_b32 s57, s57, 14
    v_mfma_f32_16x16x32_bf16 v[92:95], v[176:179], v[212:215], v[92:95]
    s_nop 0
    s_nop 0
    v_mfma_f32_16x16x32_bf16 v[96:99], v[180:183], v[212:215], v[96:99]
    s_xor_b32 s57, s57, 0
    v_lshl_add_u32 v245, v0, 4, s57
    v_mfma_f32_16x16x32_bf16 v[100:103], v[184:187], v[212:215], v[100:103]
    v_lshl_add_u32 v3, s56, 4, v2
    s_lshl1_add_u32 s57, s97, s48
    v_mfma_f32_16x16x32_bf16 v[104:107], v[188:191], v[212:215], v[104:107]
    s_lshl_b32 s57, s57, 6
    v_lshl_add_u32 v247, v3, 10, s57
    v_mfma_f32_16x16x32_bf16 v[108:111], v[192:195], v[212:215], v[108:111]
    v_lshl_add_u32 v247, v246, 5, v247
    v_lshrrev_b32 v1, 1, v1
    v_mfma_f32_16x16x32_bf16 v[112:115], v[196:199], v[212:215], v[112:115]
    v_lshl_add_u32 v247, v1, 4, v247
    v_lshlrev_b32 v246, 2, v3
    v_mfma_f32_16x16x32_bf16 v[116:119], v[200:203], v[212:215], v[116:119]
    v_add_u32 v246, 8388608, v246
    s_lshl_b32 s57, s3, 11
    v_lshl_add_u32 v252, v0, 4, s57
    v_xor_b32 v253, 8192, v252
    v_add_u32 v252, 141312, v252
    v_add_u32 v253, 141312, v253
    s_lshl_b32 s57, s49, 8
    s_add_u32 s57, s57, 157696
    v_lshl_add_u32 v254, v0, 2, s57
    s_lshr_b32 s56, s96, 1
    s_lshl_b32 s56, s56, 8
    s_add_u32 s56, s56, 9437184
    v_lshl_add_u32 v255, v2, 2, s56
    s_barrier
    ds_read_b64_tr_b16 v[156:157], v6 offset:0
    ds_read_b64_tr_b16 v[158:159], v6 offset:512
    ds_read_b64_tr_b16 v[160:161], v6 offset:8192
    ds_read_b64_tr_b16 v[162:163], v6 offset:8704
    ds_read_b64_tr_b16 v[164:165], v6 offset:16384
    ds_read_b64_tr_b16 v[166:167], v6 offset:16896
    ds_read_b128 v[120:123], v4 offset:0
    ds_read_b128 v[124:127], v4 offset:2048
    ds_read_b128 v[128:131], v4 offset:4096
    ds_read_b128 v[132:135], v4 offset:6144
    ds_read_b128 v[136:139], v4 offset:8192
    ds_read_b128 v[140:143], v4 offset:10240
    ds_read_b128 v[144:147], v4 offset:12288
    ds_read_b128 v[148:151], v4 offset:14336
    ds_read_b128 v[152:155], v4 offset:16384
    s_waitcnt lgkmcnt(0)
    s_mov_b32 s46, 0
    s_mov_b32 s47, 6
L_MAIN:
    v_mfma_f32_16x16x32_bf16 v[48:51], v[160:163], v[120:123], v[48:51]
    ds_read_b64_tr_b16 v[204:205], v6 offset:4096
    v_mfma_f32_16x16x32_bf16 v[52:55], v[160:163], v[124:127], v[52:55]
    ds_read_b64_tr_b16 v[206:207], v6 offset:4608
    v_mfma_f32_16x16x32_bf16 v[16:19], v[156:159], v[124:127], v[16:19]
    ds_read_b64_tr_b16 v[208:209], v6 offset:12288
    v_mfma_f32_16x16x32_bf16 v[20:23], v[156:159], v[128:131], v[20:23]
    ds_read_b64_tr_b16 v[210:211], v6 offset:12800
    v_mfma_f32_16x16x32_bf16 v[56:59], v[160:163], v[128:131], v[56:59]
    ds_read_b64_tr_b16 v[212:213], v6 offset:20480
    v_mfma_f32_16x16x32_bf16 v[60:63], v[160:163], v[132:135], v[60:63]
    ds_read_b64_tr_b16 v[214:215], v6 offset:20992
    v_mfma_f32_16x16x32_bf16 v[24:27], v[156:159], v[132:135], v[24:27]
    ds_read_b128 v[168:171], v5 offset:0
    v_mfma_f32_16x16x32_bf16 v[28:31], v[156:159], v[136:139], v[28:31]
    ds_read_b128 v[172:175], v5 offset:2048
    v_mfma_f32_16x16x32_bf16 v[64:67], v[160:163], v[136:139], v[64:67]
    ds_read_b128 v[176:179], v5 offset:4096
    v_mfma_f32_16x16x32_bf16 v[68:71], v[160:163], v[140:143], v[68:71]
    ds_read_b128 v[180:183], v5 offset:6144
    v_mfma_f32_16x16x32_bf16 v[32:35], v[156:159], v[140:143], v[32:35]
    ds_read_b128 v[184:187], v5 offset:8192
    v_mfma_f32_16x16x32_bf16 v[36:39], v[156:159], v[144:147], v[36:39]
    ds_read_b128 v[188:191], v5 offset:10240
    v_mfma_f32_16x16x32_bf16 v[72:75], v[160:163], v[144:147], v[72:75]
    ds_read_b128 v[192:195], v5 offset:12288
    v_mfma_f32_16x16x32_bf16 v[76:79], v[160:163], v[148:151], v[76:79]
    ds_read_b128 v[196:199], v5 offset:14336
    v_mfma_f32_16x16x32_bf16 v[40:43], v[156:159], v[148:151], v[40:43]
    ds_read_b128 v[200:203], v5 offset:16384
    v_mfma_f32_16x16x32_bf16 v[44:47], v[156:159], v[152:155], v[44:47]
    ds_read_b32 v242, v237
    v_mfma_f32_16x16x32_bf16 v[80:83], v[160:163], v[152:155], v[80:83]
    ds_read_b32 v243, v239
    v_mfma_f32_16x16x32_bf16 v[84:87], v[120:123], v[164:167], v[84:87]
    s_add_u32 s98, s98, 1
    s_cmp_gt_u32 s98, 7
    v_mfma_f32_16x16x32_bf16 v[88:91], v[124:127], v[164:167], v[88:91]
    s_cselect_b32 s98, 0, s98
    v_lshl_add_u32 v239, s98, 7, v238
    v_mfma_f32_16x16x32_bf16 v[92:95], v[128:131], v[164:167], v[92:95]
    s_sub_u32 s46, s46, 43008
    s_cselect_b32 s46, 86016, s46
    v_mfma_f32_16x16x32_bf16 v[96:99], v[132:135], v[164:167], v[96:99]
    s_sub_u32 s47, s47, 1
    v_add_u32 v4, s46, v7
    v_mfma_f32_16x16x32_bf16 v[100:103], v[136:139], v[164:167], v[100:103]
    v_add_u32 v5, s46, v8
    v_add_u32 v6, s46, v9
    v_mfma_f32_16x16x32_bf16 v[104:107], v[140:143], v[164:167], v[104:107]
    v_add_u32 v237, s46, v236
    s_cmp_lg_u32 s47, 0
    v_mfma_f32_16x16x32_bf16 v[108:111], v[144:147], v[164:167], v[108:111]
    v_mfma_f32_16x16x32_bf16 v[112:115], v[148:151], v[164:167], v[112:115]
    v_mfma_f32_16x16x32_bf16 v[116:119], v[152:155], v[164:167], v[116:119]
    s_waitcnt lgkmcnt(0)
    s_cbranch_scc0 L_LAST
    s_barrier
    v_mfma_f32_16x16x32_bf16 v[48:51], v[208:211], v[168:171], v[48:51]
    ds_read_b64_tr_b16 v[156:157], v6 offset:0
    v_mfma_f32_16x16x32_bf16 v[52:55], v[208:211], v[172:175], v[52:55]
    ds_read_b64_tr_b16 v[158:159], v6 offset:512
    v_mfma_f32_16x16x32_bf16 v[16:19], v[204:207], v[172:175], v[16:19]
    ds_read_b64_tr_b16 v[160:161], v6 offset:8192
    v_mfma_f32_16x16x32_bf16 v[20:23], v[204:207], v[176:179], v[20:23]
    ds_read_b64_tr_b16 v[162:163], v6 offset:8704
    v_mfma_f32_16x16x32_bf16 v[56:59], v[208:211], v[176:179], v[56:59]
    ds_read_b64_tr_b16 v[164:165], v6 offset:16384
    v_mfma_f32_16x16x32_bf16 v[60:63], v[208:211], v[180:183], v[60:63]
    ds_read_b64_tr_b16 v[166:167], v6 offset:16896
    v_mfma_f32_16x16x32_bf16 v[24:27], v[204:207], v[180:183], v[24:27]
    ds_read_b128 v[120:123], v4 offset:0
    v_mfma_f32_16x16x32_bf16 v[28:31], v[204:207], v[184:187], v[28:31]
    ds_read_b128 v[124:127], v4 offset:2048
    v_mfma_f32_16x16x32_bf16 v[64:67], v[208:211], v[184:187], v[64:67]
    ds_read_b128 v[128:131], v4 offset:4096
    v_mfma_f32_16x16x32_bf16 v[68:71], v[208:211], v[188:191], v[68:71]
    ds_read_b128 v[132:135], v4 offset:6144
    v_mfma_f32_16x16x32_bf16 v[32:35], v[204:207], v[188:191], v[32:35]
    ds_read_b128 v[136:139], v4 offset:8192
    v_mfma_f32_16x16x32_bf16 v[36:39], v[204:207], v[192:195], v[36:39]
    ds_read_b128 v[140:143], v4 offset:10240
    v_mfma_f32_16x16x32_bf16 v[72:75], v[208:211], v[192:195], v[72:75]
    ds_read_b128 v[144:147], v4 offset:12288
    v_mfma_f32_16x16x32_bf16 v[76:79], v[208:211], v[196:199], v[76:79]
    ds_read_b128 v[148:151], v4 offset:14336
    v_mfma_f32_16x16x32_bf16 v[40:43], v[204:207], v[196:199], v[40:43]
    ds_read_b128 v[152:155], v4 offset:16384
    v_mfma_f32_16x16x32_bf16 v[44:47], v[204:207], v[200:203], v[44:47]
    v_lshlrev_b32 v1, 16, v242
    v_mfma_f32_16x16x32_bf16 v[80:83], v[208:211], v[200:203], v[80:83]
    v_and_b32 v2, 0xffff0000, v242
    v_mfma_f32_16x16x32_bf16 v[84:87], v[168:171], v[212:215], v[84:87]
    v_lshlrev_b32 v3, 16, v243
    v_mfma_f32_16x16x32_bf16 v[88:91], v[172:175], v[212:215], v[88:91]
    v_and_b32 v15, 0xffff0000, v243
    v_mfma_f32_16x16x32_bf16 v[92:95], v[176:179], v[212:215], v[92:95]
    v_mul_f32 v1, v1, v3
    v_mfma_f32_16x16x32_bf16 v[96:99], v[180:183], v[212:215], v[96:99]
    v_mul_f32 v2, v2, v15
    v_mfma_f32_16x16x32_bf16 v[100:103], v[184:187], v[212:215], v[100:103]
    v_cvt_pk_bf16_f32 v1, v1, v2
    v_mfma_f32_16x16x32_bf16 v[104:107], v[188:191], v[212:215], v[104:107]
    v_lshlrev_b32 v3, 16, v1
    v_mfma_f32_16x16x32_bf16 v[108:111], v[192:195], v[212:215], v[108:111]
    v_and_b32 v15, 0xffff0000, v1
    v_mfma_f32_16x16x32_bf16 v[112:115], v[196:199], v[212:215], v[112:115]
    v_add_f32 v240, v240, v3
    v_mfma_f32_16x16x32_bf16 v[116:119], v[200:203], v[212:215], v[116:119]
    v_add_f32 v241, v241, v15
    s_waitcnt lgkmcnt(0)
    s_branch L_MAIN
L_LAST:
    v_add_u32 v4, 153600, v7
    v_add_u32 v5, 153600, v8
    v_add_u32 v6, 110592, v9
    v_add_u32 v237, s100, v236
    s_barrier
    v_mfma_f32_16x16x32_bf16 v[48:51], v[208:211], v[168:171], v[48:51]
    ds_read_b64_tr_b16 v[156:157], v6 offset:0
    v_mfma_f32_16x16x32_bf16 v[52:55], v[208:211], v[172:175], v[52:55]
    ds_read_b64_tr_b16 v[158:159], v6 offset:512
    v_mfma_f32_16x16x32_bf16 v[16:19], v[204:207], v[172:175], v[16:19]
    ds_read_b64_tr_b16 v[160:161], v6 offset:8192
    v_mfma_f32_16x16x32_bf16 v[20:23], v[204:207], v[176:179], v[20:23]
    ds_read_b64_tr_b16 v[162:163], v6 offset:8704
    v_mfma_f32_16x16x32_bf16 v[56:59], v[208:211], v[176:179], v[56:59]
    ds_read_b64_tr_b16 v[164:165], v6 offset:16384
    v_mfma_f32_16x16x32_bf16 v[60:63], v[208:211], v[180:183], v[60:63]
    ds_read_b64_tr_b16 v[166:167], v6 offset:16896
    v_mfma_f32_16x16x32_bf16 v[24:27], v[204:207], v[180:183], v[24:27]
    ds_read_b128 v[120:123], v4 offset:0
    v_mfma_f32_16x16x32_bf16 v[28:31], v[204:207], v[184:187], v[28:31]
    ds_read_b128 v[124:127], v4 offset:2048
    v_mfma_f32_16x16x32_bf16 v[64:67], v[208:211], v[184:187], v[64:67]
    ds_read_b128 v[128:131], v4 offset:4096
    v_mfma_f32_16x16x32_bf16 v[68:71], v[208:211], v[188:191], v[68:71]
    ds_read_b128 v[132:135], v4 offset:6144
    v_mfma_f32_16x16x32_bf16 v[32:35], v[204:207], v[188:191], v[32:35]
    ds_read_b128 v[136:139], v7 offset:0
    v_mfma_f32_16x16x32_bf16 v[36:39], v[204:207], v[192:195], v[36:39]
    ds_read_b128 v[140:143], v7 offset:2048
    v_mfma_f32_16x16x32_bf16 v[72:75], v[208:211], v[192:195], v[72:75]
    ds_read_b128 v[144:147], v7 offset:4096
    v_mfma_f32_16x16x32_bf16 v[76:79], v[208:211], v[196:199], v[76:79]
    ds_read_b128 v[148:151], v7 offset:6144
    v_mfma_f32_16x16x32_bf16 v[40:43], v[204:207], v[196:199], v[40:43]
    ds_read_b128 v[152:155], v7 offset:8192
    v_mfma_f32_16x16x32_bf16 v[44:47], v[204:207], v[200:203], v[44:47]
    v_lshlrev_b32 v1, 16, v242
    v_mfma_f32_16x16x32_bf16 v[80:83], v[208:211], v[200:203], v[80:83]
    v_and_b32 v2, 0xffff0000, v242
    v_mfma_f32_16x16x32_bf16 v[84:87], v[168:171], v[212:215], v[84:87]
    v_lshlrev_b32 v3, 16, v243
    v_mfma_f32_16x16x32_bf16 v[88:91], v[172:175], v[212:215], v[88:91]
    v_and_b32 v15, 0xffff0000, v243
    v_mfma_f32_16x16x32_bf16 v[92:95], v[176:179], v[212:215], v[92:95]
    v_mul_f32 v1, v1, v3
    v_mfma_f32_16x16x32_bf16 v[96:99], v[180:183], v[212:215], v[96:99]
    v_mul_f32 v2, v2, v15
    v_mfma_f32_16x16x32_bf16 v[100:103], v[184:187], v[212:215], v[100:103]
    v_cvt_pk_bf16_f32 v1, v1, v2
    v_mfma_f32_16x16x32_bf16 v[104:107], v[188:191], v[212:215], v[104:107]
    v_lshlrev_b32 v3, 16, v1
    v_mfma_f32_16x16x32_bf16 v[108:111], v[192:195], v[212:215], v[108:111]
    v_and_b32 v15, 0xffff0000, v1
    v_mfma_f32_16x16x32_bf16 v[112:115], v[196:199], v[212:215], v[112:115]
    v_add_f32 v240, v240, v3
    v_mfma_f32_16x16x32_bf16 v[116:119], v[200:203], v[212:215], v[116:119]
    v_add_f32 v241, v241, v15
    s_waitcnt lgkmcnt(0)
    v_mfma_f32_16x16x32_bf16 v[48:51], v[160:163], v[120:123], v[48:51]
    ds_read_b64_tr_b16 v[204:205], v6 offset:4096
    ds_read_b64_tr_b16 v[206:207], v6 offset:4608
    v_mfma_f32_16x16x32_bf16 v[52:55], v[160:163], v[124:127], v[52:55]
    ds_read_b64_tr_b16 v[208:209], v6 offset:12288
    ds_read_b64_tr_b16 v[210:211], v6 offset:12800
    v_mfma_f32_16x16x32_bf16 v[16:19], v[156:159], v[124:127], v[16:19]
    ds_read_b64_tr_b16 v[212:213], v6 offset:20480
    ds_read_b64_tr_b16 v[214:215], v6 offset:20992
    v_mfma_f32_16x16x32_bf16 v[20:23], v[156:159], v[128:131], v[20:23]
    ds_read_b128 v[168:171], v5 offset:0
    ds_read_b128 v[172:175], v5 offset:2048
    v_mfma_f32_16x16x32_bf16 v[56:59], v[160:163], v[128:131], v[56:59]
    ds_read_b128 v[176:179], v5 offset:4096
    ds_read_b128 v[180:183], v5 offset:6144
    v_mfma_f32_16x16x32_bf16 v[60:63], v[160:163], v[132:135], v[60:63]
    ds_read_b128 v[184:187], v8 offset:0
    ds_read_b128 v[188:191], v8 offset:2048
    v_mfma_f32_16x16x32_bf16 v[24:27], v[156:159], v[132:135], v[24:27]
    ds_read_b128 v[192:195], v8 offset:4096
    ds_read_b128 v[196:199], v8 offset:6144
    v_mfma_f32_16x16x32_bf16 v[28:31], v[156:159], v[136:139], v[28:31]
    ds_read_b128 v[200:203], v8 offset:8192
    ds_read_b32 v242, v237
    v_mfma_f32_16x16x32_bf16 v[64:67], v[160:163], v[136:139], v[64:67]
    ds_read_b32 v243, v239
    v_mfma_f32_16x16x32_bf16 v[84:87], v[120:123], v[164:167], v[84:87]
    v_mfma_f32_16x16x32_bf16 v[88:91], v[124:127], v[164:167], v[88:91]
    v_mfma_f32_16x16x32_bf16 v[92:95], v[128:131], v[164:167], v[92:95]
    v_mfma_f32_16x16x32_bf16 v[96:99], v[132:135], v[164:167], v[96:99]
    v_mfma_f32_16x16x32_bf16 v[100:103], v[136:139], v[164:167], v[100:103]
    s_waitcnt lgkmcnt(0)
    s_barrier
    s_setprio 2
    v_mfma_f32_16x16x32_bf16 v[48:51], v[208:211], v[168:171], v[48:51]
    v_lshlrev_b32 v1, 16, v242
    v_and_b32 v2, 0xffff0000, v242
    v_mfma_f32_16x16x32_bf16 v[52:55], v[208:211], v[172:175], v[52:55]
    v_lshlrev_b32 v3, 16, v243
    v_and_b32 v15, 0xffff0000, v243
    v_mfma_f32_16x16x32_bf16 v[16:19], v[204:207], v[172:175], v[16:19]
    v_mul_f32 v1, v1, v3
    v_mul_f32 v2, v2, v15
    v_mfma_f32_16x16x32_bf16 v[20:23], v[204:207], v[176:179], v[20:23]
    v_cvt_pk_bf16_f32 v1, v1, v2
    v_lshlrev_b32 v3, 16, v1
    v_mfma_f32_16x16x32_bf16 v[56:59], v[208:211], v[176:179], v[56:59]
    v_and_b32 v15, 0xffff0000, v1
    v_add_f32 v240, v240, v3
    v_mfma_f32_16x16x32_bf16 v[60:63], v[208:211], v[180:183], v[60:63]
    v_add_f32 v241, v241, v15
    v_add_f32 v10, v240, v241
    v_mfma_f32_16x16x32_bf16 v[24:27], v[204:207], v[180:183], v[24:27]
    v_mfma_f32_16x16x32_bf16 v[28:31], v[204:207], v[184:187], v[28:31]
    v_add_f32_dpp v10, v10, v10 row_ror:8 row_mask:0xf bank_mask:0xf
    v_mfma_f32_16x16x32_bf16 v[64:67], v[208:211], v[184:187], v[64:67]
    v_mfma_f32_16x16x32_bf16 v[84:87], v[168:171], v[212:215], v[84:87]
    v_cvt_pk_bf16_f32 v168, v48, v49
    v_cvt_pk_bf16_f32 v169, v50, v51
    v_mfma_f32_16x16x32_bf16 v[88:91], v[172:175], v[212:215], v[88:91]
    v_cvt_pk_bf16_f32 v170, v52, v53
    v_cvt_pk_bf16_f32 v171, v54, v55
    v_mfma_f32_16x16x32_bf16 v[92:95], v[176:179], v[212:215], v[92:95]
    v_cvt_pk_bf16_f32 v178, v16, v17
    v_cvt_pk_bf16_f32 v179, v18, v19
    v_mfma_f32_16x16x32_bf16 v[96:99], v[180:183], v[212:215], v[96:99]
    v_cvt_pk_bf16_f32 v172, v56, v57
    v_cvt_pk_bf16_f32 v173, v58, v59
    v_mfma_f32_16x16x32_bf16 v[100:103], v[184:187], v[212:215], v[100:103]
    v_cvt_pk_bf16_f32 v180, v20, v21
    v_cvt_pk_bf16_f32 v181, v22, v23
    v_mfma_f32_16x16x16_bf16 v[16:19], v[170:171], v[178:179], v[216:219]
    v_cvt_pk_bf16_f32 v174, v60, v61
    v_cvt_pk_bf16_f32 v175, v62, v63
    v_mfma_f32_16x16x16_bf16 v[48:51], v[168:169], v[178:179], v[224:227]
    v_cvt_pk_bf16_f32 v182, v24, v25
    v_cvt_pk_bf16_f32 v183, v26, v27
    v_mfma_f32_16x16x16_bf16 v[20:23], v[172:173], v[180:181], v[216:219]
    v_cvt_pk_bf16_f32 v176, v64, v65
    v_cvt_pk_bf16_f32 v177, v66, v67
    v_mfma_f32_16x16x16_bf16 v[52:55], v[170:171], v[180:181], v[220:223]
    v_cvt_pk_bf16_f32 v184, v28, v29
    v_cvt_pk_bf16_f32 v185, v30, v31
    v_mfma_f32_16x16x16_bf16 v[24:27], v[174:175], v[182:183], v[216:219]
    v_cvt_pk_bf16_f32 v120, v84, v85
    v_cvt_pk_bf16_f32 v122, v88, v89
    v_mfma_f32_16x16x16_bf16 v[56:59], v[172:173], v[182:183], v[220:223]
    v_cvt_pk_bf16_f32 v124, v92, v93
    v_cvt_pk_bf16_f32 v126, v96, v97
    v_mfma_f32_16x16x16_bf16 v[28:31], v[176:177], v[184:185], v[216:219]
    v_max3_f32 v84, v16, v17, v48
    v_max3_f32 v85, v18, v19, v50
    v_mfma_f32_16x16x16_bf16 v[60:63], v[174:175], v[184:185], v[220:223]
    v_max3_f32 v88, v20, v21, v52
    v_max3_f32 v89, v22, v23, v54
    v_mfma_f32_16x16x32_bf16 v[68:71], v[160:163], v[140:143], v[68:71]
    v_max3_f32 v92, v24, v25, v56
    v_max3_f32 v93, v26, v27, v58
    v_mfma_f32_16x16x32_bf16 v[32:35], v[156:159], v[140:143], v[32:35]
    v_cvt_pk_bf16_f32 v121, v86, v87
    v_cvt_pk_bf16_f32 v123, v90, v91
    v_mfma_f32_16x16x32_bf16 v[36:39], v[156:159], v[144:147], v[36:39]
    v_max3_f32 v96, v28, v29, v60
    v_max3_f32 v97, v30, v31, v62
    v_mfma_f32_16x16x32_bf16 v[72:75], v[160:163], v[144:147], v[72:75]
    v_cvt_pk_bf16_f32 v125, v94, v95
    v_cvt_pk_bf16_f32 v127, v98, v99
    v_mfma_f32_16x16x32_bf16 v[104:107], v[140:143], v[164:167], v[104:107]
    v_max_f32 v84, v84, v49
    v_max_f32 v85, v85, v51
    v_mfma_f32_16x16x32_bf16 v[108:111], v[144:147], v[164:167], v[108:111]
    v_max_f32 v88, v88, v53
    v_max_f32 v89, v89, v55
    v_mfma_f32_16x16x32_bf16 v[68:71], v[208:211], v[188:191], v[68:71]
    v_max_f32 v92, v92, v57
    v_max_f32 v93, v93, v59
    v_mfma_f32_16x16x32_bf16 v[32:35], v[204:207], v[188:191], v[32:35]
    v_max_f32 v96, v96, v61
    v_max_f32 v97, v97, v63
    v_mfma_f32_16x16x32_bf16 v[36:39], v[204:207], v[192:195], v[36:39]
    v_max_f32 v86, v84, v85
    v_max_f32 v90, v88, v89
    v_mfma_f32_16x16x32_bf16 v[72:75], v[208:211], v[192:195], v[72:75]
    v_max_f32 v94, v92, v93
    v_max_f32 v98, v96, v97
    v_mfma_f32_16x16x32_bf16 v[104:107], v[188:191], v[212:215], v[104:107]
    v_permlane32_swap_b32 v86, v90
    v_mfma_f32_16x16x32_bf16 v[108:111], v[192:195], v[212:215], v[108:111]
    v_permlane32_swap_b32 v94, v98
    v_mfma_f32_16x16x32_bf16 v[76:79], v[160:163], v[148:151], v[76:79]
    v_max_f32 v86, v86, v90
    v_max_f32 v94, v94, v98
    v_mfma_f32_16x16x32_bf16 v[40:43], v[156:159], v[148:151], v[40:43]
    v_add_f32_dpp v10, v10, v10 row_ror:4 row_mask:0xf bank_mask:0xf
    v_permlane16_swap_b32 v86, v94
    v_mfma_f32_16x16x32_bf16 v[44:47], v[156:159], v[152:155], v[44:47]
    v_max_f32 v86, v86, v94
    v_mul_f32 v86, s43, v86
    v_mfma_f32_16x16x32_bf16 v[80:83], v[160:163], v[152:155], v[80:83]
    v_mov_b32 v94, v86
    v_add_f32_dpp v10, v10, v10 row_ror:2 row_mask:0xf bank_mask:0xf
    v_mfma_f32_16x16x32_bf16 v[76:79], v[208:211], v[196:199], v[76:79]
    v_permlane16_swap_b32 v86, v94
    v_mfma_f32_16x16x32_bf16 v[40:43], v[204:207], v[196:199], v[40:43]
    v_mov_b32 v90, v86
    v_add_f32_dpp v10, v10, v10 row_ror:1 row_mask:0xf bank_mask:0xf
    v_mfma_f32_16x16x32_bf16 v[44:47], v[204:207], v[200:203], v[44:47]
    v_permlane32_swap_b32 v86, v90
    v_mfma_f32_16x16x32_bf16 v[80:83], v[208:211], v[200:203], v[80:83]
    v_pk_fma_f32 v[84:85], v[84:85], s[44:45], v[86:87] op_sel_hi:[1,0,0] neg_lo:[0,0,1] neg_hi:[0,0,1]
    v_pk_fma_f32 v[88:89], v[88:89], s[44:45], v[90:91] op_sel_hi:[1,0,0] neg_lo:[0,0,1] neg_hi:[0,0,1]
    v_mfma_f32_16x16x32_bf16 v[112:115], v[148:151], v[164:167], v[112:115]
    v_exp_f32 v84, v84
    v_mfma_f32_16x16x32_bf16 v[116:119], v[152:155], v[164:167], v[116:119]
    v_exp_f32 v85, v85
    v_mfma_f32_16x16x32_bf16 v[112:115], v[196:199], v[212:215], v[112:115]
    v_exp_f32 v88, v88
    v_mfma_f32_16x16x32_bf16 v[116:119], v[200:203], v[212:215], v[116:119]
    v_exp_f32 v89, v89
    v_cvt_pk_bf16_f32 v84, v84, v85
    v_cvt_pk_bf16_f32 v88, v88, v89
    v_perm_b32 v16, v84, v84, v228
    v_perm_b32 v17, v84, v84, v229
    v_perm_b32 v18, v84, v84, v230
    v_perm_b32 v19, v84, v84, v231
    v_perm_b32 v20, v88, v88, v228
    v_perm_b32 v21, v88, v88, v229
    v_mfma_f32_16x16x32_bf16 v[236:239], v[232:235], v[16:19], 0
    v_perm_b32 v22, v88, v88, v230
    v_perm_b32 v23, v88, v88, v231
    v_mfma_f32_16x16x32_bf16 v[48:51], v[120:123], v[16:19], 0
    v_mov_b32 v1, v10
    v_mov_b32 v98, v94
    v_mfma_f32_16x16x32_bf16 v[4:7], v[232:235], v[20:23], 0
    v_permlane16_swap_b32 v10, v1
    v_mfma_f32_16x16x32_bf16 v[52:55], v[122:125], v[20:23], 0
    v_add_f32 v10, v10, v1
    v_cvt_pk_bf16_f32 v10, v10, v10
    v_lshlrev_b32 v10, 16, v10
    v_mul_f32 v10, 0xbfb8aa3b, v10
    v_rcp_f32 v86, v236
    v_exp_f32 v10, v10
    v_rcp_f32 v90, v4
    v_pk_mul_f32 v[48:49], v[48:49], v[86:87] op_sel_hi:[1,0]
    v_pk_mul_f32 v[50:51], v[50:51], v[86:87] op_sel_hi:[1,0]
    v_pk_mul_f32 v[52:53], v[52:53], v[90:91] op_sel_hi:[1,0]
    v_pk_mul_f32 v[54:55], v[54:55], v[90:91] op_sel_hi:[1,0]
    v_add_f32 v10, 1.0, v10
    v_rcp_f32 v10, v10
    v_cvt_pk_bf16_f32 v16, v48, v49
    v_cvt_pk_bf16_f32 v17, v50, v51
    v_cvt_pk_bf16_f32 v18, v52, v53
    v_cvt_pk_bf16_f32 v19, v54, v55
    v_cvt_pk_bf16_f32 v10, v10, v10
    v_permlane16_swap_b32 v16, v18
    v_permlane16_swap_b32 v17, v19
    v_lshlrev_b32 v10, 16, v10
    buffer_store_dword v10, v11, s[32:35], 0 offen sc1
    buffer_store_dwordx4 v[16:19], v13, s[32:35], 0 offen sc1
    v_permlane32_swap_b32 v94, v98
    v_pk_fma_f32 v[92:93], v[92:93], s[44:45], v[94:95] op_sel_hi:[1,0,0] neg_lo:[0,0,1] neg_hi:[0,0,1]
    v_pk_fma_f32 v[96:97], v[96:97], s[44:45], v[98:99] op_sel_hi:[1,0,0] neg_lo:[0,0,1] neg_hi:[0,0,1]
    v_exp_f32 v92, v92
    v_exp_f32 v93, v93
    v_exp_f32 v96, v96
    v_exp_f32 v97, v97
    v_cvt_pk_bf16_f32 v92, v92, v93
    v_cvt_pk_bf16_f32 v96, v96, v97
    v_perm_b32 v24, v92, v92, v228
    v_perm_b32 v25, v92, v92, v229
    v_perm_b32 v26, v92, v92, v230
    v_perm_b32 v27, v92, v92, v231
    v_perm_b32 v28, v96, v96, v228
    v_perm_b32 v29, v96, v96, v229
    v_mfma_f32_16x16x32_bf16 v[188:191], v[232:235], v[24:27], 0
    v_perm_b32 v30, v96, v96, v230
    v_perm_b32 v31, v96, v96, v231
    v_mfma_f32_16x16x32_bf16 v[56:59], v[124:127], v[24:27], 0
    v_cvt_pk_bf16_f32 v128, v100, v101
    v_cvt_pk_bf16_f32 v129, v102, v103
    v_mfma_f32_16x16x32_bf16 v[192:195], v[232:235], v[28:31], 0
    v_cvt_pk_bf16_f32 v140, v68, v69
    v_cvt_pk_bf16_f32 v141, v70, v71
    v_mfma_f32_16x16x32_bf16 v[60:63], v[126:129], v[28:31], 0
    v_rcp_f32 v94, v188
    v_cvt_pk_bf16_f32 v148, v32, v33
    v_pk_mul_f32 v[56:57], v[56:57], v[94:95] op_sel_hi:[1,0]
    v_pk_mul_f32 v[58:59], v[58:59], v[94:95] op_sel_hi:[1,0]
    v_cvt_pk_bf16_f32 v24, v56, v57
    v_rcp_f32 v98, v192
    v_cvt_pk_bf16_f32 v25, v58, v59
    v_cvt_pk_bf16_f32 v149, v34, v35
    v_pk_mul_f32 v[60:61], v[60:61], v[98:99] op_sel_hi:[1,0]
    v_pk_mul_f32 v[62:63], v[62:63], v[98:99] op_sel_hi:[1,0]
    v_mfma_f32_16x16x16_bf16 v[32:35], v[140:141], v[148:149], v[216:219]
    v_cvt_pk_bf16_f32 v26, v60, v61
    v_cvt_pk_bf16_f32 v27, v62, v63
    v_mfma_f32_16x16x16_bf16 v[64:67], v[176:177], v[148:149], v[220:223]
    v_permlane16_swap_b32 v24, v26
    v_permlane16_swap_b32 v25, v27
    buffer_store_dwordx4 v[24:27], v13, s[32:35], s40 offen sc1
    v_cvt_pk_bf16_f32 v142, v72, v73
    v_cvt_pk_bf16_f32 v143, v74, v75
    v_cvt_pk_bf16_f32 v150, v36, v37
    v_cvt_pk_bf16_f32 v151, v38, v39
    v_cvt_pk_bf16_f32 v144, v76, v77
    v_cvt_pk_bf16_f32 v145, v78, v79
    v_mfma_f32_16x16x16_bf16 v[36:39], v[142:143], v[150:151], v[216:219]
    v_cvt_pk_bf16_f32 v152, v40, v41
    v_cvt_pk_bf16_f32 v153, v42, v43
    v_mfma_f32_16x16x16_bf16 v[68:71], v[140:141], v[150:151], v[220:223]
    v_cvt_pk_bf16_f32 v146, v80, v81
    v_cvt_pk_bf16_f32 v147, v82, v83
    v_mfma_f32_16x16x16_bf16 v[40:43], v[144:145], v[152:153], v[216:219]
    v_cvt_pk_bf16_f32 v154, v44, v45
    v_cvt_pk_bf16_f32 v155, v46, v47
    v_mfma_f32_16x16x16_bf16 v[72:75], v[142:143], v[152:153], v[220:223]
    v_cvt_pk_bf16_f32 v130, v104, v105
    v_cvt_pk_bf16_f32 v132, v108, v109
    v_mfma_f32_16x16x16_bf16 v[44:47], v[146:147], v[154:155], v[216:219]
    v_cvt_pk_bf16_f32 v134, v112, v113
    v_max3_f32 v100, v32, v33, v64
    v_mfma_f32_16x16x16_bf16 v[76:79], v[144:145], v[154:155], v[220:223]
    v_max3_f32 v101, v34, v35, v66
    v_max3_f32 v104, v36, v37, v68
    v_max3_f32 v105, v38, v39, v70
    v_max3_f32 v108, v40, v41, v72
    v_max3_f32 v109, v42, v43, v74
    v_cvt_pk_bf16_f32 v131, v106, v107
    v_cvt_pk_bf16_f32 v133, v110, v111
    v_cvt_pk_bf16_f32 v135, v114, v115
    v_max3_f32 v112, v44, v45, v76
    v_max3_f32 v113, v46, v47, v78
    v_max_f32 v100, v100, v65
    v_max_f32 v101, v101, v67
    v_max_f32 v104, v104, v69
    v_max_f32 v105, v105, v71
    v_max_f32 v108, v108, v73
    v_max_f32 v109, v109, v75
    v_max_f32 v112, v112, v77
    v_max_f32 v113, v113, v79
    v_max_f32 v102, v100, v101
    v_max_f32 v106, v104, v105
    v_max_f32 v110, v108, v109
    v_max_f32 v114, v112, v113
    v_permlane32_swap_b32 v102, v106
    v_max_f32 v102, v102, v106
    v_permlane32_swap_b32 v110, v114
    v_max_f32 v110, v110, v114
    v_cvt_pk_bf16_f32 v136, v116, v117
    v_cvt_pk_bf16_f32 v137, v118, v119
    v_permlane16_swap_b32 v102, v110
    v_max_f32 v102, v102, v110
    v_mul_f32 v102, s43, v102
    v_mov_b32 v110, v102
    s_nop 1
    v_permlane16_swap_b32 v102, v110
    v_mov_b32 v106, v102
    v_mov_b32 v114, v110
    s_nop 0
    v_permlane32_swap_b32 v102, v106
    v_permlane32_swap_b32 v110, v114
    v_pk_fma_f32 v[100:101], v[100:101], s[44:45], v[102:103] op_sel_hi:[1,0,0] neg_lo:[0,0,1] neg_hi:[0,0,1]
    v_pk_fma_f32 v[104:105], v[104:105], s[44:45], v[106:107] op_sel_hi:[1,0,0] neg_lo:[0,0,1] neg_hi:[0,0,1]
    v_pk_fma_f32 v[108:109], v[108:109], s[44:45], v[110:111] op_sel_hi:[1,0,0] neg_lo:[0,0,1] neg_hi:[0,0,1]
    v_pk_fma_f32 v[112:113], v[112:113], s[44:45], v[114:115] op_sel_hi:[1,0,0] neg_lo:[0,0,1] neg_hi:[0,0,1]
    v_exp_f32 v100, v100
    v_exp_f32 v101, v101
    v_exp_f32 v104, v104
    v_exp_f32 v105, v105
    v_exp_f32 v108, v108
    v_exp_f32 v109, v109
    v_exp_f32 v112, v112
    v_exp_f32 v113, v113
    v_cvt_pk_bf16_f32 v100, v100, v101
    v_cvt_pk_bf16_f32 v104, v104, v105
    v_cvt_pk_bf16_f32 v108, v108, v109
    v_cvt_pk_bf16_f32 v112, v112, v113
    v_perm_b32 v32, v100, v100, v228
    v_perm_b32 v33, v100, v100, v229
    v_perm_b32 v34, v100, v100, v230
    v_perm_b32 v35, v100, v100, v231
    v_perm_b32 v36, v104, v104, v228
    v_perm_b32 v37, v104, v104, v229
    v_mfma_f32_16x16x32_bf16 v[196:199], v[232:235], v[32:35], 0
    v_perm_b32 v38, v104, v104, v230
    v_perm_b32 v39, v104, v104, v231
    v_mfma_f32_16x16x32_bf16 v[64:67], v[128:131], v[32:35], 0
    v_perm_b32 v40, v108, v108, v228
    v_perm_b32 v41, v108, v108, v229
    v_mfma_f32_16x16x32_bf16 v[200:203], v[232:235], v[36:39], 0
    v_perm_b32 v42, v108, v108, v230
    v_perm_b32 v43, v108, v108, v231
    v_mfma_f32_16x16x32_bf16 v[68:71], v[130:133], v[36:39], 0
    v_perm_b32 v44, v112, v112, v228
    v_perm_b32 v45, v112, v112, v229
    v_mfma_f32_16x16x32_bf16 v[156:159], v[232:235], v[40:43], 0
    v_perm_b32 v46, v112, v112, v230
    v_perm_b32 v47, v112, v112, v231
    v_mfma_f32_16x16x32_bf16 v[72:75], v[132:135], v[40:43], 0
    v_rcp_f32 v102, v196
    v_mfma_f32_16x16x32_bf16 v[160:163], v[232:235], v[44:47], 0
    v_rcp_f32 v106, v200
    v_mfma_f32_16x16x32_bf16 v[76:79], v[134:137], v[44:47], 0
    v_pk_mul_f32 v[64:65], v[64:65], v[102:103] op_sel_hi:[1,0]
    v_rcp_f32 v110, v156
    v_pk_mul_f32 v[66:67], v[66:67], v[102:103] op_sel_hi:[1,0]
    v_pk_mul_f32 v[68:69], v[68:69], v[106:107] op_sel_hi:[1,0]
    v_pk_mul_f32 v[70:71], v[70:71], v[106:107] op_sel_hi:[1,0]
    v_pk_mul_f32 v[72:73], v[72:73], v[110:111] op_sel_hi:[1,0]
    v_rcp_f32 v114, v160
    v_pk_mul_f32 v[74:75], v[74:75], v[110:111] op_sel_hi:[1,0]
    v_pk_mul_f32 v[76:77], v[76:77], v[114:115] op_sel_hi:[1,0]
    v_pk_mul_f32 v[78:79], v[78:79], v[114:115] op_sel_hi:[1,0]
    v_cvt_pk_bf16_f32 v32, v64, v65
    v_cvt_pk_bf16_f32 v33, v66, v67
    v_cvt_pk_bf16_f32 v34, v68, v69
    v_cvt_pk_bf16_f32 v35, v70, v71
    v_cvt_pk_bf16_f32 v40, v72, v73
    v_cvt_pk_bf16_f32 v41, v74, v75
    v_cvt_pk_bf16_f32 v42, v76, v77
    v_cvt_pk_bf16_f32 v43, v78, v79
    v_permlane16_swap_b32 v32, v34
    v_permlane16_swap_b32 v33, v35
    v_permlane16_swap_b32 v40, v42
    v_permlane16_swap_b32 v41, v43
    buffer_store_dwordx4 v[32:35], v13, s[32:35], s41 offen sc1
    buffer_store_dwordx4 v[40:43], v13, s[32:35], s42 offen sc1
    ds_read_b32 v2, v12 offset:4
    v_mov_b32 v15, 1
    s_mov_b32 s58, 262144
    v_mov_b32 v1, v245
    v_mov_b32 v3, v246
    v_mov_b32 v8, v247
    v_mov_b32 v4, v248
    v_mov_b32 v5, v249
    v_mov_b32 v6, v250
    v_mov_b32 v7, v251
    v_mov_b32 v9, v252
    v_mov_b32 v0, v255
    s_mov_b64 exec, 1
    s_waitcnt vmcnt(0)
    ds_add_rtn_u32 v10, v12, v15
    s_waitcnt lgkmcnt(0)
    v_cmp_eq_u32 vcc, 3, v10
    s_cbranch_vccz L_NOFLAG0
    buffer_store_dword v15, v14, s[32:35], 0 offen sc1
L_NOFLAG0:
    s_mov_b64 exec, -1
    v_mov_b32 v14, v253
    v_mov_b32 v13, v254
K_P2:
L_WOW:
    s_waitcnt lgkmcnt(0)
    v_cmp_eq_u32 vcc, 4, v2
    s_cbranch_vccnz L_WOK
    ds_read_b32 v2, v12 offset:4
    s_branch L_WOW
L_WOK:
    s_cmp_eq_u32 s49, 0
    s_cbranch_scc0 np_20
    buffer_load_dword v11, v0, s[32:35], 0 offen sc1
np_20:
    ds_read_b64_tr_b16 v[96:97], v4 offset:12288
    ds_read_b64_tr_b16 v[98:99], v4 offset:12800
    ds_read_b64_tr_b16 v[100:101], v5 offset:12288
    ds_read_b64_tr_b16 v[102:103], v5 offset:12800
    ds_read_b64_tr_b16 v[104:105], v6 offset:12288
    ds_read_b64_tr_b16 v[106:107], v6 offset:12800
    ds_read_b64_tr_b16 v[108:109], v7 offset:12288
    ds_read_b64_tr_b16 v[110:111], v7 offset:12800
    ds_read_b64_tr_b16 v[112:113], v4 offset:16384
    ds_read_b64_tr_b16 v[114:115], v4 offset:16896
    ds_read_b64_tr_b16 v[116:117], v5 offset:16384
    ds_read_b64_tr_b16 v[118:119], v5 offset:16896
    ds_read_b64_tr_b16 v[120:121], v6 offset:16384
    ds_read_b64_tr_b16 v[122:123], v6 offset:16896
    ds_read_b64_tr_b16 v[124:125], v7 offset:16384
    ds_read_b64_tr_b16 v[126:127], v7 offset:16896
    ds_read_b64_tr_b16 v[128:129], v4 offset:20480
    ds_read_b64_tr_b16 v[130:131], v4 offset:20992
    ds_read_b64_tr_b16 v[132:133], v5 offset:20480
    ds_read_b64_tr_b16 v[134:135], v5 offset:20992
    ds_read_b64_tr_b16 v[136:137], v6 offset:20480
    ds_read_b64_tr_b16 v[138:139], v6 offset:20992
    ds_read_b64_tr_b16 v[140:141], v7 offset:20480
    ds_read_b64_tr_b16 v[142:143], v7 offset:20992
    ds_read_b64_tr_b16 v[144:145], v4 offset:24576
    ds_read_b64_tr_b16 v[146:147], v4 offset:25088
    ds_read_b64_tr_b16 v[148:149], v5 offset:24576
    ds_read_b64_tr_b16 v[150:151], v5 offset:25088
    ds_read_b64_tr_b16 v[152:153], v6 offset:24576
    ds_read_b64_tr_b16 v[154:155], v6 offset:25088
    ds_read_b64_tr_b16 v[156:157], v7 offset:24576
    ds_read_b64_tr_b16 v[158:159], v7 offset:25088
    ds_read_b64_tr_b16 v[160:161], v4 offset:28672
    ds_read_b64_tr_b16 v[162:163], v4 offset:29184
    ds_read_b64_tr_b16 v[164:165], v5 offset:28672
    ds_read_b64_tr_b16 v[166:167], v5 offset:29184
    ds_read_b64_tr_b16 v[168:169], v6 offset:28672
    ds_read_b64_tr_b16 v[170:171], v6 offset:29184
    ds_read_b64_tr_b16 v[172:173], v7 offset:28672
    ds_read_b64_tr_b16 v[174:175], v7 offset:29184
    s_cmp_eq_u32 s49, 0
    s_cbranch_scc0 np_21
    buffer_load_dword v11, v0, s[32:35], 0 offen sc1
np_21:
    ds_read_b64_tr_b16 v[176:177], v4 offset:45056
    ds_read_b64_tr_b16 v[178:179], v4 offset:45568
    ds_read_b64_tr_b16 v[180:181], v5 offset:45056
    ds_read_b64_tr_b16 v[182:183], v5 offset:45568
    ds_read_b64_tr_b16 v[184:185], v6 offset:45056
    ds_read_b64_tr_b16 v[186:187], v6 offset:45568
    ds_read_b64_tr_b16 v[188:189], v7 offset:45056
    ds_read_b64_tr_b16 v[190:191], v7 offset:45568
    ds_read_b64_tr_b16 v[192:193], v4 offset:49152
    ds_read_b64_tr_b16 v[194:195], v4 offset:49664
    ds_read_b64_tr_b16 v[196:197], v5 offset:49152
    ds_read_b64_tr_b16 v[198:199], v5 offset:49664
    ds_read_b64_tr_b16 v[200:201], v6 offset:49152
    ds_read_b64_tr_b16 v[202:203], v6 offset:49664
    ds_read_b64_tr_b16 v[204:205], v7 offset:49152
    ds_read_b64_tr_b16 v[206:207], v7 offset:49664
    ds_read_b64_tr_b16 v[208:209], v4 offset:53248
    ds_read_b64_tr_b16 v[210:211], v4 offset:53760
    ds_read_b64_tr_b16 v[212:213], v5 offset:53248
    ds_read_b64_tr_b16 v[214:215], v5 offset:53760
    ds_read_b64_tr_b16 v[216:217], v6 offset:53248
    ds_read_b64_tr_b16 v[218:219], v6 offset:53760
    ds_read_b64_tr_b16 v[220:221], v7 offset:53248
    ds_read_b64_tr_b16 v[222:223], v7 offset:53760
    ds_read_b64_tr_b16 v[224:225], v4 offset:57344
    ds_read_b64_tr_b16 v[226:227], v4 offset:57856
    ds_read_b64_tr_b16 v[228:229], v5 offset:57344
    ds_read_b64_tr_b16 v[230:231], v5 offset:57856
    ds_read_b64_tr_b16 v[232:233], v6 offset:57344
    ds_read_b64_tr_b16 v[234:235], v6 offset:57856
    ds_read_b64_tr_b16 v[236:237], v7 offset:57344
    ds_read_b64_tr_b16 v[238:239], v7 offset:57856
    ds_read_b64_tr_b16 v[240:241], v4 offset:61440
    ds_read_b64_tr_b16 v[242:243], v4 offset:61952
    ds_read_b64_tr_b16 v[244:245], v5 offset:61440
    ds_read_b64_tr_b16 v[246:247], v5 offset:61952
    ds_read_b64_tr_b16 v[248:249], v6 offset:61440
    ds_read_b64_tr_b16 v[250:251], v6 offset:61952
    ds_read_b64_tr_b16 v[252:253], v7 offset:61440
    ds_read_b64_tr_b16 v[254:255], v7 offset:61952
    s_cmp_eq_u32 s49, 0
    s_cbranch_scc0 foll_22
    s_sub_u32 s58, s58, 1
    s_cselect_b32 s59, -1, 0
    s_waitcnt vmcnt(1)
    v_cmp_eq_u32 vcc, 1, v11
    s_nop 0
    s_or_b32 s59, s59, vcc_lo
    v_mov_b32 v2, s59
    s_mov_b64 exec, 1
    ds_or_b32 v12, v2 offset:8
    s_mov_b64 exec, -1
    s_branch refd_23
foll_22:
    ds_read_b32 v2, v12 offset:8
    s_waitcnt lgkmcnt(0)
    v_readfirstlane_b32 s59, v2
refd_23:
L_W1:
    s_and_b32 s56, s59, s54
    s_cmp_eq_u32 s56, s54
    s_cbranch_scc1 L_VA
    s_and_b32 s56, s59, s55
    s_cmp_eq_u32 s56, s55
    s_cbranch_scc1 L_VB
    s_cmp_eq_u32 s49, 0
    s_cbranch_scc0 foll_24
    buffer_load_dword v11, v0, s[32:35], 0 offen sc1
    s_sub_u32 s58, s58, 1
    s_cselect_b32 s59, -1, 0
    s_waitcnt vmcnt(1)
    v_cmp_eq_u32 vcc, 1, v11
    s_nop 0
    s_or_b32 s59, s59, vcc_lo
    v_mov_b32 v2, s59
    s_mov_b64 exec, 1
    ds_or_b32 v12, v2 offset:8
    s_mov_b64 exec, -1
    s_branch refd_25
foll_24:
    ds_read_b32 v2, v12 offset:8
    s_waitcnt lgkmcnt(0)
    v_readfirstlane_b32 s59, v2
refd_25:
    s_branch L_W1
L_VA:
    buffer_load_dwordx4 v[48:51], v1, s[32:35], s4 offen sc1
    buffer_load_dwordx4 v[52:55], v1, s[32:35], s5 offen sc1
    buffer_load_dwordx4 v[56:59], v1, s[32:35], s6 offen sc1
    buffer_load_dwordx4 v[60:63], v1, s[32:35], s7 offen sc1
    s_cmp_eq_u32 s49, 0
    s_cbranch_scc0 np_26
    buffer_load_dword v11, v0, s[32:35], 0 offen sc1
np_26:
    ds_read_b64_tr_b16 v[64:65], v4 offset:0
    ds_read_b64_tr_b16 v[66:67], v4 offset:512
    ds_read_b64_tr_b16 v[68:69], v5 offset:0
    ds_read_b64_tr_b16 v[70:71], v5 offset:512
    ds_read_b64_tr_b16 v[72:73], v6 offset:0
    ds_read_b64_tr_b16 v[74:75], v6 offset:512
    ds_read_b64_tr_b16 v[76:77], v7 offset:0
    ds_read_b64_tr_b16 v[78:79], v7 offset:512
    ds_read_b64_tr_b16 v[80:81], v4 offset:4096
    ds_read_b64_tr_b16 v[82:83], v4 offset:4608
    ds_read_b64_tr_b16 v[84:85], v5 offset:4096
    ds_read_b64_tr_b16 v[86:87], v5 offset:4608
    ds_read_b64_tr_b16 v[88:89], v6 offset:4096
    ds_read_b64_tr_b16 v[90:91], v6 offset:4608
    ds_read_b64_tr_b16 v[92:93], v7 offset:4096
    ds_read_b64_tr_b16 v[94:95], v7 offset:4608
    s_waitcnt lgkmcnt(8)
    s_waitcnt vmcnt(3)
    v_mfma_f32_16x16x32_bf16 v[16:19], v[64:67], v[48:51], 0
    v_mfma_f32_16x16x32_bf16 v[20:23], v[68:71], v[48:51], 0
    v_mfma_f32_16x16x32_bf16 v[24:27], v[72:75], v[48:51], 0
    v_mfma_f32_16x16x32_bf16 v[28:31], v[76:79], v[48:51], 0
    ds_read_b64_tr_b16 v[64:65], v4 offset:8192
    ds_read_b64_tr_b16 v[66:67], v4 offset:8704
    ds_read_b64_tr_b16 v[68:69], v5 offset:8192
    ds_read_b64_tr_b16 v[70:71], v5 offset:8704
    ds_read_b64_tr_b16 v[72:73], v6 offset:8192
    ds_read_b64_tr_b16 v[74:75], v6 offset:8704
    ds_read_b64_tr_b16 v[76:77], v7 offset:8192
    ds_read_b64_tr_b16 v[78:79], v7 offset:8704
    buffer_load_dwordx4 v[48:51], v1, s[32:35], s8 offen sc1
    s_waitcnt lgkmcnt(8)
    s_waitcnt vmcnt(3)
    v_mfma_f32_16x16x32_bf16 v[16:19], v[80:83], v[52:55], v[16:19]
    v_mfma_f32_16x16x32_bf16 v[20:23], v[84:87], v[52:55], v[20:23]
    v_mfma_f32_16x16x32_bf16 v[24:27], v[88:91], v[52:55], v[24:27]
    v_mfma_f32_16x16x32_bf16 v[28:31], v[92:95], v[52:55], v[28:31]
    ds_read_b64_tr_b16 v[80:81], v4 offset:32768
    ds_read_b64_tr_b16 v[82:83], v4 offset:33280
    ds_read_b64_tr_b16 v[84:85], v5 offset:32768
    ds_read_b64_tr_b16 v[86:87], v5 offset:33280
    ds_read_b64_tr_b16 v[88:89], v6 offset:32768
    ds_read_b64_tr_b16 v[90:91], v6 offset:33280
    ds_read_b64_tr_b16 v[92:93], v7 offset:32768
    ds_read_b64_tr_b16 v[94:95], v7 offset:33280
    buffer_load_dwordx4 v[52:55], v1, s[32:35], s9 offen sc1
    s_waitcnt lgkmcnt(8)
    s_waitcnt vmcnt(3)
    v_mfma_f32_16x16x32_bf16 v[16:19], v[64:67], v[56:59], v[16:19]
    v_mfma_f32_16x16x32_bf16 v[20:23], v[68:71], v[56:59], v[20:23]
    v_mfma_f32_16x16x32_bf16 v[24:27], v[72:75], v[56:59], v[24:27]
    v_mfma_f32_16x16x32_bf16 v[28:31], v[76:79], v[56:59], v[28:31]
    ds_read_b64_tr_b16 v[64:65], v4 offset:36864
    ds_read_b64_tr_b16 v[66:67], v4 offset:37376
    ds_read_b64_tr_b16 v[68:69], v5 offset:36864
    ds_read_b64_tr_b16 v[70:71], v5 offset:37376
    ds_read_b64_tr_b16 v[72:73], v6 offset:36864
    ds_read_b64_tr_b16 v[74:75], v6 offset:37376
    ds_read_b64_tr_b16 v[76:77], v7 offset:36864
    ds_read_b64_tr_b16 v[78:79], v7 offset:37376
    buffer_load_dwordx4 v[56:59], v1, s[32:35], s10 offen sc1
    s_waitcnt vmcnt(3)
    v_mfma_f32_16x16x32_bf16 v[16:19], v[96:99], v[60:63], v[16:19]
    v_mfma_f32_16x16x32_bf16 v[20:23], v[100:103], v[60:63], v[20:23]
    v_mfma_f32_16x16x32_bf16 v[24:27], v[104:107], v[60:63], v[24:27]
    v_mfma_f32_16x16x32_bf16 v[28:31], v[108:111], v[60:63], v[28:31]
    s_cmp_eq_u32 s49, 0
    s_cbranch_scc0 foll_27
    s_sub_u32 s58, s58, 1
    s_cselect_b32 s59, -1, 0
    v_cmp_eq_u32 vcc, 1, v11
    s_nop 0
    s_or_b32 s59, s59, vcc_lo
    v_mov_b32 v2, s59
    s_mov_b64 exec, 1
    ds_or_b32 v12, v2 offset:8
    s_mov_b64 exec, -1
foll_27:
    buffer_load_dwordx4 v[60:63], v1, s[32:35], s11 offen sc1
    s_waitcnt vmcnt(3)
    v_mfma_f32_16x16x32_bf16 v[16:19], v[112:115], v[48:51], v[16:19]
    v_mfma_f32_16x16x32_bf16 v[20:23], v[116:119], v[48:51], v[20:23]
    v_mfma_f32_16x16x32_bf16 v[24:27], v[120:123], v[48:51], v[24:27]
    v_mfma_f32_16x16x32_bf16 v[28:31], v[124:127], v[48:51], v[28:31]
    s_and_b32 s56, s59, s55
    s_cmp_eq_u32 s56, s55
    s_cbranch_scc1 w2ok_30
    s_cmp_eq_u32 s49, 0
    s_cbranch_scc0 np_31
    buffer_load_dword v11, v0, s[32:35], 0 offen sc1
np_31:
w2_29:
    s_cmp_eq_u32 s49, 0
    s_cbranch_scc0 foll_32
    buffer_load_dword v11, v0, s[32:35], 0 offen sc1
    s_sub_u32 s58, s58, 1
    s_cselect_b32 s59, -1, 0
    s_waitcnt vmcnt(1)
    v_cmp_eq_u32 vcc, 1, v11
    s_nop 0
    s_or_b32 s59, s59, vcc_lo
    v_mov_b32 v2, s59
    s_mov_b64 exec, 1
    ds_or_b32 v12, v2 offset:8
    s_mov_b64 exec, -1
    s_branch refd_33
foll_32:
    ds_read_b32 v2, v12 offset:8
    s_waitcnt lgkmcnt(0)
    v_readfirstlane_b32 s59, v2
refd_33:
    s_and_b32 s56, s59, s55
    s_cmp_eq_u32 s56, s55
    s_cbranch_scc0 w2_29
w2ok_30:
    buffer_load_dwordx4 v[48:51], v1, s[32:35], s12 offen sc1
    s_waitcnt vmcnt(3)
    v_mfma_f32_16x16x32_bf16 v[16:19], v[128:131], v[52:55], v[16:19]
    v_mfma_f32_16x16x32_bf16 v[20:23], v[132:135], v[52:55], v[20:23]
    v_mfma_f32_16x16x32_bf16 v[24:27], v[136:139], v[52:55], v[24:27]
    v_mfma_f32_16x16x32_bf16 v[28:31], v[140:143], v[52:55], v[28:31]
    buffer_load_dwordx4 v[52:55], v1, s[32:35], s13 offen sc1
    s_waitcnt vmcnt(3)
    v_mfma_f32_16x16x32_bf16 v[16:19], v[144:147], v[56:59], v[16:19]
    v_mfma_f32_16x16x32_bf16 v[20:23], v[148:151], v[56:59], v[20:23]
    v_mfma_f32_16x16x32_bf16 v[24:27], v[152:155], v[56:59], v[24:27]
    v_mfma_f32_16x16x32_bf16 v[28:31], v[156:159], v[56:59], v[28:31]
    buffer_load_dwordx4 v[56:59], v1, s[32:35], s14 offen sc1
    s_waitcnt vmcnt(3)
    v_mfma_f32_16x16x32_bf16 v[16:19], v[160:163], v[60:63], v[16:19]
    v_mfma_f32_16x16x32_bf16 v[20:23], v[164:167], v[60:63], v[20:23]
    v_mfma_f32_16x16x32_bf16 v[24:27], v[168:171], v[60:63], v[24:27]
    v_mfma_f32_16x16x32_bf16 v[28:31], v[172:175], v[60:63], v[28:31]
    buffer_load_dwordx4 v[60:63], v1, s[32:35], s15 offen sc1
    s_waitcnt lgkmcnt(8)
    s_waitcnt vmcnt(3)
    v_mfma_f32_16x16x32_bf16 v[32:35], v[80:83], v[48:51], 0
    v_mfma_f32_16x16x32_bf16 v[36:39], v[84:87], v[48:51], 0
    v_mfma_f32_16x16x32_bf16 v[40:43], v[88:91], v[48:51], 0
    v_mfma_f32_16x16x32_bf16 v[44:47], v[92:95], v[48:51], 0
    ds_read_b64_tr_b16 v[80:81], v4 offset:40960
    ds_read_b64_tr_b16 v[82:83], v4 offset:41472
    ds_read_b64_tr_b16 v[84:85], v5 offset:40960
    ds_read_b64_tr_b16 v[86:87], v5 offset:41472
    ds_read_b64_tr_b16 v[88:89], v6 offset:40960
    ds_read_b64_tr_b16 v[90:91], v6 offset:41472
    ds_read_b64_tr_b16 v[92:93], v7 offset:40960
    ds_read_b64_tr_b16 v[94:95], v7 offset:41472
    buffer_load_dwordx4 v[48:51], v1, s[32:35], s16 offen sc1
    s_waitcnt lgkmcnt(8)
    s_waitcnt vmcnt(3)
    v_mfma_f32_16x16x32_bf16 v[32:35], v[64:67], v[52:55], v[32:35]
    v_mfma_f32_16x16x32_bf16 v[36:39], v[68:71], v[52:55], v[36:39]
    v_mfma_f32_16x16x32_bf16 v[40:43], v[72:75], v[52:55], v[40:43]
    v_mfma_f32_16x16x32_bf16 v[44:47], v[76:79], v[52:55], v[44:47]
    buffer_load_dwordx4 v[52:55], v1, s[32:35], s17 offen sc1
    s_waitcnt lgkmcnt(0)
    s_waitcnt vmcnt(3)
    v_mfma_f32_16x16x32_bf16 v[32:35], v[80:83], v[56:59], v[32:35]
    v_mfma_f32_16x16x32_bf16 v[36:39], v[84:87], v[56:59], v[36:39]
    v_mfma_f32_16x16x32_bf16 v[40:43], v[88:91], v[56:59], v[40:43]
    v_mfma_f32_16x16x32_bf16 v[44:47], v[92:95], v[56:59], v[44:47]
    buffer_load_dwordx4 v[56:59], v1, s[32:35], s18 offen sc1
    s_waitcnt vmcnt(3)
    v_mfma_f32_16x16x32_bf16 v[32:35], v[176:179], v[60:63], v[32:35]
    v_mfma_f32_16x16x32_bf16 v[36:39], v[180:183], v[60:63], v[36:39]
    v_mfma_f32_16x16x32_bf16 v[40:43], v[184:187], v[60:63], v[40:43]
    v_mfma_f32_16x16x32_bf16 v[44:47], v[188:191], v[60:63], v[44:47]
    buffer_load_dwordx4 v[60:63], v1, s[32:35], s19 offen sc1
    s_waitcnt vmcnt(3)
    v_mfma_f32_16x16x32_bf16 v[32:35], v[192:195], v[48:51], v[32:35]
    v_mfma_f32_16x16x32_bf16 v[36:39], v[196:199], v[48:51], v[36:39]
    v_mfma_f32_16x16x32_bf16 v[40:43], v[200:203], v[48:51], v[40:43]
    v_mfma_f32_16x16x32_bf16 v[44:47], v[204:207], v[48:51], v[44:47]
    buffer_load_dword v10, v3, s[32:35], 0 offen sc1
    s_waitcnt vmcnt(3)
    v_mfma_f32_16x16x32_bf16 v[32:35], v[208:211], v[52:55], v[32:35]
    v_mfma_f32_16x16x32_bf16 v[36:39], v[212:215], v[52:55], v[36:39]
    v_mfma_f32_16x16x32_bf16 v[40:43], v[216:219], v[52:55], v[40:43]
    v_mfma_f32_16x16x32_bf16 v[44:47], v[220:223], v[52:55], v[44:47]
    s_waitcnt vmcnt(2)
    v_mfma_f32_16x16x32_bf16 v[32:35], v[224:227], v[56:59], v[32:35]
    v_mfma_f32_16x16x32_bf16 v[36:39], v[228:231], v[56:59], v[36:39]
    v_mfma_f32_16x16x32_bf16 v[40:43], v[232:235], v[56:59], v[40:43]
    v_mfma_f32_16x16x32_bf16 v[44:47], v[236:239], v[56:59], v[44:47]
    s_waitcnt vmcnt(1)
    v_mfma_f32_16x16x32_bf16 v[32:35], v[240:243], v[60:63], v[32:35]
    v_mfma_f32_16x16x32_bf16 v[36:39], v[244:247], v[60:63], v[36:39]
    v_mfma_f32_16x16x32_bf16 v[40:43], v[248:251], v[60:63], v[40:43]
    v_mfma_f32_16x16x32_bf16 v[44:47], v[252:255], v[60:63], v[44:47]
    s_branch L_VEND
L_VB:
    buffer_load_dwordx4 v[48:51], v1, s[32:35], s12 offen sc1
    buffer_load_dwordx4 v[52:55], v1, s[32:35], s13 offen sc1
    buffer_load_dwordx4 v[56:59], v1, s[32:35], s14 offen sc1
    buffer_load_dwordx4 v[60:63], v1, s[32:35], s15 offen sc1
    s_cmp_eq_u32 s49, 0
    s_cbranch_scc0 np_34
    buffer_load_dword v11, v0, s[32:35], 0 offen sc1
np_34:
    ds_read_b64_tr_b16 v[64:65], v4 offset:32768
    ds_read_b64_tr_b16 v[66:67], v4 offset:33280
    ds_read_b64_tr_b16 v[68:69], v5 offset:32768
    ds_read_b64_tr_b16 v[70:71], v5 offset:33280
    ds_read_b64_tr_b16 v[72:73], v6 offset:32768
    ds_read_b64_tr_b16 v[74:75], v6 offset:33280
    ds_read_b64_tr_b16 v[76:77], v7 offset:32768
    ds_read_b64_tr_b16 v[78:79], v7 offset:33280
    ds_read_b64_tr_b16 v[80:81], v4 offset:36864
    ds_read_b64_tr_b16 v[82:83], v4 offset:37376
    ds_read_b64_tr_b16 v[84:85], v5 offset:36864
    ds_read_b64_tr_b16 v[86:87], v5 offset:37376
    ds_read_b64_tr_b16 v[88:89], v6 offset:36864
    ds_read_b64_tr_b16 v[90:91], v6 offset:37376
    ds_read_b64_tr_b16 v[92:93], v7 offset:36864
    ds_read_b64_tr_b16 v[94:95], v7 offset:37376
    s_waitcnt lgkmcnt(8)
    s_waitcnt vmcnt(3)
    v_mfma_f32_16x16x32_bf16 v[32:35], v[64:67], v[48:51], 0
    v_mfma_f32_16x16x32_bf16 v[36:39], v[68:71], v[48:51], 0
    v_mfma_f32_16x16x32_bf16 v[40:43], v[72:75], v[48:51], 0
    v_mfma_f32_16x16x32_bf16 v[44:47], v[76:79], v[48:51], 0
    ds_read_b64_tr_b16 v[64:65], v4 offset:40960
    ds_read_b64_tr_b16 v[66:67], v4 offset:41472
    ds_read_b64_tr_b16 v[68:69], v5 offset:40960
    ds_read_b64_tr_b16 v[70:71], v5 offset:41472
    ds_read_b64_tr_b16 v[72:73], v6 offset:40960
    ds_read_b64_tr_b16 v[74:75], v6 offset:41472
    ds_read_b64_tr_b16 v[76:77], v7 offset:40960
    ds_read_b64_tr_b16 v[78:79], v7 offset:41472
    buffer_load_dwordx4 v[48:51], v1, s[32:35], s16 offen sc1
    s_waitcnt lgkmcnt(8)
    s_waitcnt vmcnt(3)
    v_mfma_f32_16x16x32_bf16 v[32:35], v[80:83], v[52:55], v[32:35]
    v_mfma_f32_16x16x32_bf16 v[36:39], v[84:87], v[52:55], v[36:39]
    v_mfma_f32_16x16x32_bf16 v[40:43], v[88:91], v[52:55], v[40:43]
    v_mfma_f32_16x16x32_bf16 v[44:47], v[92:95], v[52:55], v[44:47]
    ds_read_b64_tr_b16 v[80:81], v4 offset:0
    ds_read_b64_tr_b16 v[82:83], v4 offset:512
    ds_read_b64_tr_b16 v[84:85], v5 offset:0
    ds_read_b64_tr_b16 v[86:87], v5 offset:512
    ds_read_b64_tr_b16 v[88:89], v6 offset:0
    ds_read_b64_tr_b16 v[90:91], v6 offset:512
    ds_read_b64_tr_b16 v[92:93], v7 offset:0
    ds_read_b64_tr_b16 v[94:95], v7 offset:512
    buffer_load_dwordx4 v[52:55], v1, s[32:35], s17 offen sc1
    s_waitcnt lgkmcnt(8)
    s_waitcnt vmcnt(3)
    v_mfma_f32_16x16x32_bf16 v[32:35], v[64:67], v[56:59], v[32:35]
    v_mfma_f32_16x16x32_bf16 v[36:39], v[68:71], v[56:59], v[36:39]
    v_mfma_f32_16x16x32_bf16 v[40:43], v[72:75], v[56:59], v[40:43]
    v_mfma_f32_16x16x32_bf16 v[44:47], v[76:79], v[56:59], v[44:47]
    ds_read_b64_tr_b16 v[64:65], v4 offset:4096
    ds_read_b64_tr_b16 v[66:67], v4 offset:4608
    ds_read_b64_tr_b16 v[68:69], v5 offset:4096
    ds_read_b64_tr_b16 v[70:71], v5 offset:4608
    ds_read_b64_tr_b16 v[72:73], v6 offset:4096
    ds_read_b64_tr_b16 v[74:75], v6 offset:4608
    ds_read_b64_tr_b16 v[76:77], v7 offset:4096
    ds_read_b64_tr_b16 v[78:79], v7 offset:4608
    buffer_load_dwordx4 v[56:59], v1, s[32:35], s18 offen sc1
    s_waitcnt vmcnt(3)
    v_mfma_f32_16x16x32_bf16 v[32:35], v[176:179], v[60:63], v[32:35]
    v_mfma_f32_16x16x32_bf16 v[36:39], v[180:183], v[60:63], v[36:39]
    v_mfma_f32_16x16x32_bf16 v[40:43], v[184:187], v[60:63], v[40:43]
    v_mfma_f32_16x16x32_bf16 v[44:47], v[188:191], v[60:63], v[44:47]
    s_cmp_eq_u32 s49, 0
    s_cbranch_scc0 foll_35
    s_sub_u32 s58, s58, 1
    s_cselect_b32 s59, -1, 0
    v_cmp_eq_u32 vcc, 1, v11
    s_nop 0
    s_or_b32 s59, s59, vcc_lo
    v_mov_b32 v2, s59
    s_mov_b64 exec, 1
    ds_or_b32 v12, v2 offset:8
    s_mov_b64 exec, -1
foll_35:
    buffer_load_dwordx4 v[60:63], v1, s[32:35], s19 offen sc1
    s_waitcnt vmcnt(3)
    v_mfma_f32_16x16x32_bf16 v[32:35], v[192:195], v[48:51], v[32:35]
    v_mfma_f32_16x16x32_bf16 v[36:39], v[196:199], v[48:51], v[36:39]
    v_mfma_f32_16x16x32_bf16 v[40:43], v[200:203], v[48:51], v[40:43]
    v_mfma_f32_16x16x32_bf16 v[44:47], v[204:207], v[48:51], v[44:47]
    s_and_b32 s56, s59, s54
    s_cmp_eq_u32 s56, s54
    s_cbranch_scc1 w2ok_38
    s_cmp_eq_u32 s49, 0
    s_cbranch_scc0 np_39
    buffer_load_dword v11, v0, s[32:35], 0 offen sc1
np_39:
w2_37:
    s_cmp_eq_u32 s49, 0
    s_cbranch_scc0 foll_40
    buffer_load_dword v11, v0, s[32:35], 0 offen sc1
    s_sub_u32 s58, s58, 1
    s_cselect_b32 s59, -1, 0
    s_waitcnt vmcnt(1)
    v_cmp_eq_u32 vcc, 1, v11
    s_nop 0
    s_or_b32 s59, s59, vcc_lo
    v_mov_b32 v2, s59
    s_mov_b64 exec, 1
    ds_or_b32 v12, v2 offset:8
    s_mov_b64 exec, -1
    s_branch refd_41
foll_40:
    ds_read_b32 v2, v12 offset:8
    s_waitcnt lgkmcnt(0)
    v_readfirstlane_b32 s59, v2
refd_41:
    s_and_b32 s56, s59, s54
    s_cmp_eq_u32 s56, s54
    s_cbranch_scc0 w2_37
w2ok_38:
    buffer_load_dwordx4 v[48:51], v1, s[32:35], s4 offen sc1
    s_waitcnt vmcnt(3)
    v_mfma_f32_16x16x32_bf16 v[32:35], v[208:211], v[52:55], v[32:35]
    v_mfma_f32_16x16x32_bf16 v[36:39], v[212:215], v[52:55], v[36:39]
    v_mfma_f32_16x16x32_bf16 v[40:43], v[216:219], v[52:55], v[40:43]
    v_mfma_f32_16x16x32_bf16 v[44:47], v[220:223], v[52:55], v[44:47]
    buffer_load_dwordx4 v[52:55], v1, s[32:35], s5 offen sc1
    s_waitcnt vmcnt(3)
    v_mfma_f32_16x16x32_bf16 v[32:35], v[224:227], v[56:59], v[32:35]
    v_mfma_f32_16x16x32_bf16 v[36:39], v[228:231], v[56:59], v[36:39]
    v_mfma_f32_16x16x32_bf16 v[40:43], v[232:235], v[56:59], v[40:43]
    v_mfma_f32_16x16x32_bf16 v[44:47], v[236:239], v[56:59], v[44:47]
    buffer_load_dwordx4 v[56:59], v1, s[32:35], s6 offen sc1
    s_waitcnt vmcnt(3)
    v_mfma_f32_16x16x32_bf16 v[32:35], v[240:243], v[60:63], v[32:35]
    v_mfma_f32_16x16x32_bf16 v[36:39], v[244:247], v[60:63], v[36:39]
    v_mfma_f32_16x16x32_bf16 v[40:43], v[248:251], v[60:63], v[40:43]
    v_mfma_f32_16x16x32_bf16 v[44:47], v[252:255], v[60:63], v[44:47]
    buffer_load_dwordx4 v[60:63], v1, s[32:35], s7 offen sc1
    s_waitcnt lgkmcnt(8)
    s_waitcnt vmcnt(3)
    v_mfma_f32_16x16x32_bf16 v[16:19], v[80:83], v[48:51], 0
    v_mfma_f32_16x16x32_bf16 v[20:23], v[84:87], v[48:51], 0
    v_mfma_f32_16x16x32_bf16 v[24:27], v[88:91], v[48:51], 0
    v_mfma_f32_16x16x32_bf16 v[28:31], v[92:95], v[48:51], 0
    ds_read_b64_tr_b16 v[80:81], v4 offset:8192
    ds_read_b64_tr_b16 v[82:83], v4 offset:8704
    ds_read_b64_tr_b16 v[84:85], v5 offset:8192
    ds_read_b64_tr_b16 v[86:87], v5 offset:8704
    ds_read_b64_tr_b16 v[88:89], v6 offset:8192
    ds_read_b64_tr_b16 v[90:91], v6 offset:8704
    ds_read_b64_tr_b16 v[92:93], v7 offset:8192
    ds_read_b64_tr_b16 v[94:95], v7 offset:8704
    buffer_load_dwordx4 v[48:51], v1, s[32:35], s8 offen sc1
    s_waitcnt lgkmcnt(8)
    s_waitcnt vmcnt(3)
    v_mfma_f32_16x16x32_bf16 v[16:19], v[64:67], v[52:55], v[16:19]
    v_mfma_f32_16x16x32_bf16 v[20:23], v[68:71], v[52:55], v[20:23]
    v_mfma_f32_16x16x32_bf16 v[24:27], v[72:75], v[52:55], v[24:27]
    v_mfma_f32_16x16x32_bf16 v[28:31], v[76:79], v[52:55], v[28:31]
    buffer_load_dwordx4 v[52:55], v1, s[32:35], s9 offen sc1
    s_waitcnt lgkmcnt(0)
    s_waitcnt vmcnt(3)
    v_mfma_f32_16x16x32_bf16 v[16:19], v[80:83], v[56:59], v[16:19]
    v_mfma_f32_16x16x32_bf16 v[20:23], v[84:87], v[56:59], v[20:23]
    v_mfma_f32_16x16x32_bf16 v[24:27], v[88:91], v[56:59], v[24:27]
    v_mfma_f32_16x16x32_bf16 v[28:31], v[92:95], v[56:59], v[28:31]
    buffer_load_dwordx4 v[56:59], v1, s[32:35], s10 offen sc1
    s_waitcnt vmcnt(3)
    v_mfma_f32_16x16x32_bf16 v[16:19], v[96:99], v[60:63], v[16:19]
    v_mfma_f32_16x16x32_bf16 v[20:23], v[100:103], v[60:63], v[20:23]
    v_mfma_f32_16x16x32_bf16 v[24:27], v[104:107], v[60:63], v[24:27]
    v_mfma_f32_16x16x32_bf16 v[28:31], v[108:111], v[60:63], v[28:31]
    buffer_load_dwordx4 v[60:63], v1, s[32:35], s11 offen sc1
    s_waitcnt vmcnt(3)
    v_mfma_f32_16x16x32_bf16 v[16:19], v[112:115], v[48:51], v[16:19]
    v_mfma_f32_16x16x32_bf16 v[20:23], v[116:119], v[48:51], v[20:23]
    v_mfma_f32_16x16x32_bf16 v[24:27], v[120:123], v[48:51], v[24:27]
    v_mfma_f32_16x16x32_bf16 v[28:31], v[124:127], v[48:51], v[28:31]
    buffer_load_dword v10, v3, s[32:35], 0 offen sc1
    s_waitcnt vmcnt(3)
    v_mfma_f32_16x16x32_bf16 v[16:19], v[128:131], v[52:55], v[16:19]
    v_mfma_f32_16x16x32_bf16 v[20:23], v[132:135], v[52:55], v[20:23]
    v_mfma_f32_16x16x32_bf16 v[24:27], v[136:139], v[52:55], v[24:27]
    v_mfma_f32_16x16x32_bf16 v[28:31], v[140:143], v[52:55], v[28:31]
    s_waitcnt vmcnt(2)
    v_mfma_f32_16x16x32_bf16 v[16:19], v[144:147], v[56:59], v[16:19]
    v_mfma_f32_16x16x32_bf16 v[20:23], v[148:151], v[56:59], v[20:23]
    v_mfma_f32_16x16x32_bf16 v[24:27], v[152:155], v[56:59], v[24:27]
    v_mfma_f32_16x16x32_bf16 v[28:31], v[156:159], v[56:59], v[28:31]
    s_waitcnt vmcnt(1)
    v_mfma_f32_16x16x32_bf16 v[16:19], v[160:163], v[60:63], v[16:19]
    v_mfma_f32_16x16x32_bf16 v[20:23], v[164:167], v[60:63], v[20:23]
    v_mfma_f32_16x16x32_bf16 v[24:27], v[168:171], v[60:63], v[24:27]
    v_mfma_f32_16x16x32_bf16 v[28:31], v[172:175], v[60:63], v[28:31]
L_VEND:
    s_waitcnt vmcnt(0)
    s_cmp_eq_u32 s50, 0
    s_cbranch_scc0 K2_NOG
    ds_write_b32 v13, v10
K2_NOG:
    s_cmp_eq_u32 s48, 0
    s_cselect_b64 s[40:41], -1, 0
    s_nop 0
    v_pk_add_f32 v[16:17], v[16:17], v[32:33]
    v_pk_add_f32 v[18:19], v[18:19], v[34:35]
    v_pk_add_f32 v[20:21], v[20:21], v[36:37]
    v_pk_add_f32 v[22:23], v[22:23], v[38:39]
    ds_write_b128 v9, v[16:19]
    ds_write_b128 v9, v[20:23] offset:1024
    v_pk_add_f32 v[24:25], v[24:25], v[40:41]
    v_pk_add_f32 v[26:27], v[26:27], v[42:43]
    v_pk_add_f32 v[28:29], v[28:29], v[44:45]
    v_pk_add_f32 v[30:31], v[30:31], v[46:47]
    s_waitcnt lgkmcnt(0)
    s_barrier
    ds_read_b32 v10, v13
    ds_read_b128 v[48:51], v14
    ds_read_b128 v[52:55], v14 offset:1024
    s_waitcnt lgkmcnt(2)
    v_sub_f32 v11, 1.0, v10
    v_cvt_pk_bf16_f32 v11, v11, v11
    v_lshlrev_b32 v11, 16, v11
    v_cndmask_b32 v60, v11, v10, s[40:41]
    v_cndmask_b32 v62, v10, v11, s[40:41]
    v_pk_mul_f32 v[24:25], v[24:25], v[60:61] op_sel_hi:[1,0]
    v_pk_mul_f32 v[26:27], v[26:27], v[60:61] op_sel_hi:[1,0]
    v_pk_mul_f32 v[28:29], v[28:29], v[60:61] op_sel_hi:[1,0]
    v_pk_mul_f32 v[30:31], v[30:31], v[60:61] op_sel_hi:[1,0]
    s_waitcnt lgkmcnt(0)
    v_pk_fma_f32 v[24:25], v[48:49], v[62:63], v[24:25] op_sel_hi:[1,0,1]
    v_pk_fma_f32 v[26:27], v[50:51], v[62:63], v[26:27] op_sel_hi:[1,0,1]
    v_pk_fma_f32 v[28:29], v[52:53], v[62:63], v[28:29] op_sel_hi:[1,0,1]
    v_pk_fma_f32 v[30:31], v[54:55], v[62:63], v[30:31] op_sel_hi:[1,0,1]
    v_cvt_pk_bf16_f32 v56, v24, v25
    v_cvt_pk_bf16_f32 v58, v28, v29
    v_cvt_pk_bf16_f32 v57, v26, v27
    v_cvt_pk_bf16_f32 v59, v30, v31
    s_nop 0
    v_permlane16_swap_b32 v56, v58
    v_permlane16_swap_b32 v57, v59
    buffer_store_dwordx4 v[56:59], v8, s[36:39], 0 offen sc1
K2_FIN:
K_END:
    s_endpgm
.section .rodata,"a"
.p2align 6
.amdhsa_kernel gated_mix__sliding_local_dilated__sliding_local_dilated__prompt_kernel
.amdhsa_next_free_vgpr 256
.amdhsa_next_free_sgpr 102
.amdhsa_accum_offset 256
.amdhsa_group_segment_fixed_size 0
.amdhsa_kernarg_size 80
.amdhsa_user_sgpr_count 2
.amdhsa_user_sgpr_kernarg_segment_ptr 1
.amdhsa_system_sgpr_workgroup_id_x 1
.amdhsa_float_denorm_mode_32 3
.end_amdhsa_kernel
```
